```python
import torch

def _softmax(x, axis=-1):
    return torch.softmax(x, dim=axis)
def _gelu(x):
    return torch.nn.functional.gelu(x, approximate="tanh")
def _silu(x):
    return torch.nn.functional.silu(x)
def _sigmoid(x):
    return torch.sigmoid(x)
def _layernorm(x, axis=-1, eps=1e-5):
    m = x.mean(dim=axis, keepdim=True)
    v = x.var(dim=axis, keepdim=True, unbiased=False)
    return (x - m) / torch.sqrt(v + eps)
def _scatter_add(tgt, idx, src, axis=0):
    return tgt.clone().index_add_(axis, idx, src)
def _segment_sum(src, seg, n):
    out = torch.zeros((n,) + src.shape[1:], dtype=src.dtype)
    return out.index_add_(0, seg, src)
def _pad(x, pw):
    flat = tuple(v for pair in reversed(pw) for v in pair)
    return torch.nn.functional.pad(x, flat)

kernel_name = 'interleave_layers__linear_attn_block__dense_activation_silu__prompt'

def setup_inputs():

    _w = (lambda a: (lambda t: t.to(torch.bfloat16) if t.is_floating_point() else t)(torch.as_tensor(a)))
    def _A_setup():
        B, S, D = 1, 2048, 1024
        return {
            "x": _w((lambda *s: torch.randn(*s, dtype=torch.bfloat16) * 0.05)(B, S, D)),
            "wqkv": _w((lambda *s: torch.randn(*s, dtype=torch.bfloat16) * 0.05)(D, 3 * D)),
            "wo": _w((lambda *s: torch.randn(*s, dtype=torch.bfloat16) * 0.05)(D, D)),
        }
    _A_in = _A_setup()

    def _B_setup():
        B, S, D, F = 1, 2048, 1024, 3584
        return {
            "x": _w((lambda *s: torch.randn(*s, dtype=torch.bfloat16) * 0.05)(B, S, D)),
            "w1": _w((lambda *s: torch.randn(*s, dtype=torch.bfloat16) * 3.2)(D, F) * (D ** -0.5)),
            "w2": _w((lambda *s: torch.randn(*s, dtype=torch.bfloat16) * 0.8)(F, D) * (F ** -0.5)),
        }
    _B_in = _B_setup()

    return {
        "A_x": _A_in["x"],
        "A_wqkv": _A_in["wqkv"],
        "A_wo": _A_in["wo"],
        "B_x": _B_in["x"],
        "B_w1": _B_in["w1"],
        "B_w2": _B_in["w2"],
    }

def reference(A_x, A_wqkv, A_wo, B_x, B_w1, B_w2):
    def _A_ref(x, wqkv, wo):
        B, S, D = x.shape
        H = 32; Dh = D // H
        qkv = (lambda x, *d: x.permute(*d))((x @ wqkv).reshape(B, S, 3, H, Dh), 2, 0, 3, 1, 4)
        q, k, v = qkv[0], qkv[1], qkv[2]
        phi = lambda t: torch.where(t > 0, t + 1, torch.exp(t)) + 1e-6
        pq, pk = phi(q), phi(k)
        kv = torch.einsum("bhsd,bhse->bhde", pk, v)
        z = torch.einsum("bhsd->bhd", pk)
        num = torch.einsum("bhqd,bhde->bhqe", pq, kv)
        den = torch.einsum("bhqd,bhd->bhq", pq, z)[..., None] + 1e-6
        o = num / den
        return (lambda x, *d: x.permute(*d))(o, 0, 2, 1, 3).reshape(B, S, D) @ wo

    def _B_ref(x, w1, w2):
        h = torch.einsum("bsd,df->bsf", x, w1)
        h = _silu(h)
        out = torch.einsum("bsf,fd->bsd", h, w2)
        return out

    x = A_x
    x = x + _A_ref(_layernorm(x, axis=-1), A_wqkv, A_wo)
    x = x + _B_ref(_layernorm(x, axis=-1), B_w1, B_w2)
    x = x + _A_ref(_layernorm(x, axis=-1), A_wqkv, A_wo)
    x = x + _B_ref(_layernorm(x, axis=-1), B_w1, B_w2)
    return x
```

```asm
; @launch grid=(256,1,1) block=(512,1,1) lds=163840
  .amdgcn_target "amdgcn-amd-amdhsa--gfx950"
  .text
  .globl interleave_layers__linear_attn_block__dense_activation_silu__prompt_kernel
  .p2align 8
  .type interleave_layers__linear_attn_block__dense_activation_silu__prompt_kernel,@function
interleave_layers__linear_attn_block__dense_activation_silu__prompt_kernel:
  s_cmp_ge_u32 s2, 256
  s_cbranch_scc1 L_done
  s_load_dwordx16 s[4:19], s[0:1], 0
  s_load_dwordx2 s[20:21], s[0:1], 64
  v_lshrrev_b32 v1, 6, v0
  s_nop 0
  v_readfirstlane_b32 s48, v1
  s_and_b32 s52, s2, 7
  s_lshr_b32 s59, s2, 3
  s_and_b32 s72, s52, 1
  s_lshl_b32 s72, s72, 3
  s_and_b32 s60, s59, 7
  s_add_u32 s72, s72, s60
  s_lshr_b32 s73, s52, 1
  s_lshl_b32 s73, s73, 2
  s_lshr_b32 s60, s59, 3
  s_add_u32 s73, s73, s60
  s_and_b32 s74, s52, 3
  s_lshl_b32 s74, s74, 2
  s_and_b32 s60, s59, 3
  s_add_u32 s74, s74, s60
  s_lshr_b32 s75, s52, 2
  s_lshl_b32 s75, s75, 3
  s_lshr_b32 s60, s59, 2
  s_add_u32 s60, s60, 0
  s_and_b32 s60, s60, 7
  s_add_u32 s75, s75, s60
  s_mov_b32 s71, 0
  s_waitcnt lgkmcnt(0)
  s_add_u32 s76, s20, 35651584
  s_addc_u32 s77, s21, 0
  s_mov_b32 s78, 32768
  s_mov_b32 s79, 0x00020000
  s_cmp_ge_u32 s48, 4
  s_cbranch_scc1 L_loader
  s_setprio 0
  v_and_b32 v255, 63, v0
  s_cmp_eq_u32 s48, 0
  s_cbranch_scc1 L_nopf_1
  s_getpc_b64 s[58:59]
L_pc_2:
  s_sub_u32 s58, s58, L_pc_2-interleave_layers__linear_attn_block__dense_activation_silu__prompt_kernel
  s_subb_u32 s59, s59, 0
  s_sub_u32 s52, s48, 1
  s_mul_i32 s52, s52, 16384
  v_lshlrev_b32 v1, 7, v255
  v_add_u32 v1, s52, v1
  v_min_u32 v2, 34812, v1
  global_load_dword v250, v2, s[58:59]
  v_add_u32 v1, 8192, v1
  v_min_u32 v2, 34812, v1
  global_load_dword v251, v2, s[58:59]
  v_add_u32 v1, 8192, v1
L_nopf_1:
  s_lshr_b32 s90, s48, 1
  s_and_b32 s91, s48, 1
  s_cmp_lg_u32 s48, 0
  s_cbranch_scc1 L_noinit_3
  v_lshlrev_b32 v1, 2, v255
  v_mov_b32 v2, 0
  s_lshl_b32 s52, s2, 7
  s_mov_b64 exec, 0xffffffff
  buffer_store_dword v2, v1, s[76:79], s52 offen sc1
  s_mov_b64 exec, 1
  s_waitcnt vmcnt(0)
  s_and_b32 s52, s2, 3
  s_lshl_b32 s52, s52, 6
  v_mov_b32 v1, s52
  v_mov_b32 v2, 1
  s_mov_b32 s44, s18
  s_mov_b32 s45, s19
  s_mov_b32 s46, 256
  s_mov_b32 s47, 0x00020000
  buffer_atomic_add v2, v1, s[44:47], 0 offen sc1
  s_mov_b64 exec, -1
L_noinit_3:
L_clayer_4:
  s_lshl_b32 s61, s90, 6
  v_lshrrev_b32 v240, 4, v255
  v_bfe_u32 v241, v255, 2, 2
  v_lshl_add_u32 v239, v240, 3, v241
  v_lshlrev_b32 v239, 7, v239
  v_and_b32 v242, 3, v255
  v_lshl_add_u32 v239, v242, 3, v239
  v_add_u32 v239, 16384, v239
  v_and_b32 v240, 1, v240
  v_lshlrev_b32 v240, 1, v240
  v_lshrrev_b32 v241, 1, v241
  v_or_b32 v238, v240, v241
  s_lshl_b32 s52, s91, 1
  s_add_u32 s52, s52, 0
  v_xor_b32 v240, s52, v238
  v_lshl_add_u32 v224, v240, 5, v239
  s_lshl_b32 s52, s91, 1
  s_add_u32 s52, s52, 1
  v_xor_b32 v240, s52, v238
  v_lshl_add_u32 v225, v240, 5, v239
  v_lshrrev_b32 v240, 4, v255
  v_and_b32 v241, 15, v255
  s_lshl_b32 s52, s91, 7
  s_add_u32 s52, s52, 148480
  v_lshlrev_b32 v231, 4, v240
  v_add_u32 v231, s52, v231
  v_lshlrev_b32 v232, 2, v241
  v_add_u32 v232, s52, v232
  v_add_u32 v243, s61, v241
  v_lshlrev_b32 v233, 2, v243
  v_add_u32 v233, 147456, v233
  v_lshlrev_b32 v229, 2, v240
  v_add_u32 v229, s61, v229
  v_lshlrev_b32 v229, 2, v229
  v_add_u32 v229, 147456, v229
  v_lshlrev_b32 v230, 5, v243
  v_lshl_add_u32 v230, v240, 3, v230
  v_mov_b32 v226, 0x358637bd
  s_mul_i32 s52, s91, 6144
  s_add_u32 s52, s52, 98304
  v_lshlrev_b32 v234, 4, v255
  v_add_u32 v234, s52, v234
  s_mul_i32 s59, s71, 3145728
  s_add_u32 s59, s59, 27262976
  s_lshl_b32 s52, s72, 5
  s_lshl_b32 s60, s73, 1
  s_add_u32 s52, s52, s60
  s_add_u32 s52, s52, s91
  s_mul_i32 s52, s52, 2112
  s_add_u32 s59, s59, s52
  s_add_u32 s36, s20, s59
  s_addc_u32 s37, s21, 0
  s_mov_b32 s38, 2112
  s_mov_b32 s39, 0x00020000
  s_mul_i32 s59, s71, 3145728
  s_add_u32 s59, s59, 27262976
  s_lshr_b32 s52, s48, 1
  s_lshl_b32 s52, s52, 7
  s_lshl_b32 s60, s73, 1
  s_add_u32 s52, s52, s60
  s_and_b32 s60, s48, 1
  s_add_u32 s52, s52, s60
  s_mul_i32 s52, s52, 2112
  s_add_u32 s59, s59, s52
  s_add_u32 s24, s20, s59
  s_addc_u32 s25, s21, 0
  s_mov_b32 s26, 204864
  s_mov_b32 s27, 0x00020000
  v_lshlrev_b32 v235, 4, v255
  v_lshrrev_b32 v228, 4, v255
  v_lshlrev_b32 v228, 4, v228
  v_add_u32 v228, 2048, v228
  s_mul_i32 s59, s72, 262144
  s_add_u32 s32, s20, s59
  s_addc_u32 s33, s21, 0
  s_mov_b32 s34, 262144
  s_mov_b32 s35, 0x00020000
  s_lshl_b32 s59, s73, 2
  s_lshl_b32 s60, s91, 1
  s_add_u32 s59, s59, s60
  s_lshl_b32 s80, s59, 12
  s_add_u32 s81, s80, 4096
  s_lshl_b32 s82, s71, 4
  s_add_u32 s82, s82, s73
  s_add_u32 s82, s82, 0
  s_lshl_b32 s82, s82, 7
  v_mov_b32 v0, 0
  v_mov_b32 v1, 0
  v_mov_b32 v2, 0
  v_mov_b32 v3, 0
  v_mov_b32 v4, 0
  v_mov_b32 v5, 0
  v_mov_b32 v6, 0
  v_mov_b32 v7, 0
  v_mov_b32 v8, 0
  v_mov_b32 v9, 0
  v_mov_b32 v10, 0
  v_mov_b32 v11, 0
  v_mov_b32 v12, 0
  v_mov_b32 v13, 0
  v_mov_b32 v14, 0
  v_mov_b32 v15, 0
  v_mov_b32 v16, 0
  v_mov_b32 v17, 0
  v_mov_b32 v18, 0
  v_mov_b32 v19, 0
  v_mov_b32 v20, 0
  v_mov_b32 v21, 0
  v_mov_b32 v22, 0
  v_mov_b32 v23, 0
  v_mov_b32 v24, 0
  v_mov_b32 v25, 0
  v_mov_b32 v26, 0
  v_mov_b32 v27, 0
  v_mov_b32 v28, 0
  v_mov_b32 v29, 0
  v_mov_b32 v30, 0
  v_mov_b32 v31, 0
  v_mov_b32 v32, 0
  v_mov_b32 v33, 0
  v_mov_b32 v34, 0
  v_mov_b32 v35, 0
  v_mov_b32 v36, 0
  v_mov_b32 v37, 0
  v_mov_b32 v38, 0
  v_mov_b32 v39, 0
  v_mov_b32 v40, 0
  v_mov_b32 v41, 0
  v_mov_b32 v42, 0
  v_mov_b32 v43, 0
  v_mov_b32 v44, 0
  v_mov_b32 v45, 0
  v_mov_b32 v46, 0
  v_mov_b32 v47, 0
  v_mov_b32 v48, 0
  v_mov_b32 v49, 0
  v_mov_b32 v50, 0
  v_mov_b32 v51, 0
  v_mov_b32 v52, 0
  v_mov_b32 v53, 0
  v_mov_b32 v54, 0
  v_mov_b32 v55, 0
  v_mov_b32 v56, 0
  v_mov_b32 v57, 0
  v_mov_b32 v58, 0
  v_mov_b32 v59, 0
  v_mov_b32 v60, 0
  v_mov_b32 v61, 0
  v_mov_b32 v62, 0
  v_mov_b32 v63, 0
  v_mov_b32 v64, 0
  v_mov_b32 v65, 0
  v_mov_b32 v66, 0
  v_mov_b32 v67, 0
  v_mov_b32 v68, 0
  v_mov_b32 v69, 0
  v_mov_b32 v70, 0
  v_mov_b32 v71, 0
  v_mov_b32 v72, 0
  v_mov_b32 v73, 0
  v_mov_b32 v74, 0
  v_mov_b32 v75, 0
  v_mov_b32 v76, 0
  v_mov_b32 v77, 0
  v_mov_b32 v78, 0
  v_mov_b32 v79, 0
  v_mov_b32 v80, 0
  v_mov_b32 v81, 0
  v_mov_b32 v82, 0
  v_mov_b32 v83, 0
  v_mov_b32 v84, 0
  v_mov_b32 v85, 0
  v_mov_b32 v86, 0
  v_mov_b32 v87, 0
  v_mov_b32 v88, 0
  v_mov_b32 v89, 0
  v_mov_b32 v90, 0
  v_mov_b32 v91, 0
  v_mov_b32 v92, 0
  v_mov_b32 v93, 0
  v_mov_b32 v94, 0
  v_mov_b32 v95, 0
  s_cmp_lg_u32 s71, 0
  s_cbranch_scc1 L_a_l1_5
  v_and_b32 v237, 15, v255
  v_add_u32 v237, s61, v237
  v_lshlrev_b32 v237, 7, v237
  v_bfe_u32 v236, v255, 1, 3
  v_lshrrev_b32 v240, 4, v255
  v_xor_b32 v236, v236, v240
  v_lshl_add_u32 v236, v236, 4, v237
  v_xor_b32 v237, 64, v236
  s_mov_b32 s95, 12
  s_mov_b32 s53, 16
  s_mov_b32 s51, 40960
  s_mov_b32 s62, 40960
  s_barrier
  ds_read_b128 v[96:99], v236 offset:0
  ds_read_b128 v[100:103], v236 offset:2048
  ds_read_b128 v[104:107], v236 offset:4096
  ds_read_b128 v[108:111], v236 offset:6144
  ds_read_b64_tr_b16 v[128:129], v224 offset:0
  ds_read_b64_tr_b16 v[130:131], v224 offset:512
  ds_read_b64_tr_b16 v[132:133], v225 offset:0
  ds_read_b64_tr_b16 v[134:135], v225 offset:512
  ds_read_b64_tr_b16 v[136:137], v224 offset:8192
  ds_read_b64_tr_b16 v[138:139], v224 offset:8704
  ds_read_b64_tr_b16 v[140:141], v225 offset:8192
  ds_read_b64_tr_b16 v[142:143], v225 offset:8704
  ds_read_b64_tr_b16 v[144:145], v224 offset:16384
  ds_read_b64_tr_b16 v[146:147], v224 offset:16896
  ds_read_b64_tr_b16 v[148:149], v225 offset:16384
  ds_read_b64_tr_b16 v[150:151], v225 offset:16896
  .p2align 3
L_cl_7:
  s_waitcnt lgkmcnt(0)
  v_mfma_f32_16x16x32_bf16 v[0:3], v[128:131], v[96:99], v[0:3]
  ds_read_b128 v[112:115], v237 offset:0
  v_mfma_f32_16x16x32_bf16 v[24:27], v[128:131], v[100:103], v[24:27]
  ds_read_b128 v[116:119], v237 offset:2048
  v_mfma_f32_16x16x32_bf16 v[48:51], v[128:131], v[104:107], v[48:51]
  ds_read_b128 v[120:123], v237 offset:4096
  v_mfma_f32_16x16x32_bf16 v[72:75], v[128:131], v[108:111], v[72:75]
  ds_read_b128 v[124:127], v237 offset:6144
  v_mfma_f32_16x16x32_bf16 v[4:7], v[132:135], v[96:99], v[4:7]
  ds_read_b64_tr_b16 v[152:153], v224 offset:4096
  v_mfma_f32_16x16x32_bf16 v[28:31], v[132:135], v[100:103], v[28:31]
  ds_read_b64_tr_b16 v[154:155], v224 offset:4608
  v_mfma_f32_16x16x32_bf16 v[52:55], v[132:135], v[104:107], v[52:55]
  ds_read_b64_tr_b16 v[156:157], v225 offset:4096
  v_mfma_f32_16x16x32_bf16 v[76:79], v[132:135], v[108:111], v[76:79]
  ds_read_b64_tr_b16 v[158:159], v225 offset:4608
  v_mfma_f32_16x16x32_bf16 v[8:11], v[96:99], v[136:139], v[8:11]
  ds_read_b64_tr_b16 v[160:161], v224 offset:12288
  v_mfma_f32_16x16x32_bf16 v[32:35], v[100:103], v[136:139], v[32:35]
  ds_read_b64_tr_b16 v[162:163], v224 offset:12800
  v_mfma_f32_16x16x32_bf16 v[56:59], v[104:107], v[136:139], v[56:59]
  ds_read_b64_tr_b16 v[164:165], v225 offset:12288
  v_mfma_f32_16x16x32_bf16 v[80:83], v[108:111], v[136:139], v[80:83]
  ds_read_b64_tr_b16 v[166:167], v225 offset:12800
  v_mfma_f32_16x16x32_bf16 v[12:15], v[96:99], v[140:143], v[12:15]
  ds_read_b64_tr_b16 v[168:169], v224 offset:20480
  v_mfma_f32_16x16x32_bf16 v[36:39], v[100:103], v[140:143], v[36:39]
  ds_read_b64_tr_b16 v[170:171], v224 offset:20992
  v_mfma_f32_16x16x32_bf16 v[60:63], v[104:107], v[140:143], v[60:63]
  ds_read_b64_tr_b16 v[172:173], v225 offset:20480
  v_mfma_f32_16x16x32_bf16 v[84:87], v[108:111], v[140:143], v[84:87]
  ds_read_b64_tr_b16 v[174:175], v225 offset:20992
  v_mfma_f32_16x16x32_bf16 v[16:19], v[96:99], v[144:147], v[16:19]
  v_add_u32 v236, s62, v236
  v_mfma_f32_16x16x32_bf16 v[40:43], v[100:103], v[144:147], v[40:43]
  v_add_u32 v237, s62, v237
  v_mfma_f32_16x16x32_bf16 v[64:67], v[104:107], v[144:147], v[64:67]
  v_add_u32 v224, s62, v224
  v_mfma_f32_16x16x32_bf16 v[88:91], v[108:111], v[144:147], v[88:91]
  v_add_u32 v225, s62, v225
  v_mfma_f32_16x16x32_bf16 v[20:23], v[96:99], v[148:151], v[20:23]
  s_cmp_eq_u32 s95, s53
  v_mfma_f32_16x16x32_bf16 v[44:47], v[100:103], v[148:151], v[44:47]
  s_cbranch_scc1 L_hk_8
L_hb_9:
  v_mfma_f32_16x16x32_bf16 v[68:71], v[104:107], v[148:151], v[68:71]
  v_mfma_f32_16x16x32_bf16 v[92:95], v[108:111], v[148:151], v[92:95]
  s_waitcnt lgkmcnt(0)
  v_mfma_f32_16x16x32_bf16 v[0:3], v[152:155], v[112:115], v[0:3]
  s_barrier
  v_mfma_f32_16x16x32_bf16 v[24:27], v[152:155], v[116:119], v[24:27]
  ds_read_b128 v[96:99], v236 offset:0
  v_mfma_f32_16x16x32_bf16 v[48:51], v[152:155], v[120:123], v[48:51]
  ds_read_b128 v[100:103], v236 offset:2048
  v_mfma_f32_16x16x32_bf16 v[72:75], v[152:155], v[124:127], v[72:75]
  ds_read_b128 v[104:107], v236 offset:4096
  v_mfma_f32_16x16x32_bf16 v[4:7], v[156:159], v[112:115], v[4:7]
  ds_read_b128 v[108:111], v236 offset:6144
  v_mfma_f32_16x16x32_bf16 v[28:31], v[156:159], v[116:119], v[28:31]
  ds_read_b64_tr_b16 v[128:129], v224 offset:0
  v_mfma_f32_16x16x32_bf16 v[52:55], v[156:159], v[120:123], v[52:55]
  ds_read_b64_tr_b16 v[130:131], v224 offset:512
  v_mfma_f32_16x16x32_bf16 v[76:79], v[156:159], v[124:127], v[76:79]
  ds_read_b64_tr_b16 v[132:133], v225 offset:0
  v_mfma_f32_16x16x32_bf16 v[8:11], v[112:115], v[160:163], v[8:11]
  ds_read_b64_tr_b16 v[134:135], v225 offset:512
  v_mfma_f32_16x16x32_bf16 v[32:35], v[116:119], v[160:163], v[32:35]
  ds_read_b64_tr_b16 v[136:137], v224 offset:8192
  v_mfma_f32_16x16x32_bf16 v[56:59], v[120:123], v[160:163], v[56:59]
  ds_read_b64_tr_b16 v[138:139], v224 offset:8704
  v_mfma_f32_16x16x32_bf16 v[80:83], v[124:127], v[160:163], v[80:83]
  ds_read_b64_tr_b16 v[140:141], v225 offset:8192
  v_mfma_f32_16x16x32_bf16 v[12:15], v[112:115], v[164:167], v[12:15]
  ds_read_b64_tr_b16 v[142:143], v225 offset:8704
  v_mfma_f32_16x16x32_bf16 v[36:39], v[116:119], v[164:167], v[36:39]
  ds_read_b64_tr_b16 v[144:145], v224 offset:16384
  v_mfma_f32_16x16x32_bf16 v[60:63], v[120:123], v[164:167], v[60:63]
  ds_read_b64_tr_b16 v[146:147], v224 offset:16896
  v_mfma_f32_16x16x32_bf16 v[84:87], v[124:127], v[164:167], v[84:87]
  ds_read_b64_tr_b16 v[148:149], v225 offset:16384
  v_mfma_f32_16x16x32_bf16 v[16:19], v[112:115], v[168:171], v[16:19]
  ds_read_b64_tr_b16 v[150:151], v225 offset:16896
  v_mfma_f32_16x16x32_bf16 v[40:43], v[116:119], v[168:171], v[40:43]
  s_add_u32 s52, s51, 40960
  v_mfma_f32_16x16x32_bf16 v[64:67], v[120:123], v[168:171], v[64:67]
  s_cmp_eq_u32 s52, 122880
  v_mfma_f32_16x16x32_bf16 v[88:91], v[124:127], v[168:171], v[88:91]
  s_cselect_b32 s52, 0, s52
  v_mfma_f32_16x16x32_bf16 v[20:23], v[112:115], v[172:175], v[20:23]
  s_sub_u32 s62, s52, s51
  v_mfma_f32_16x16x32_bf16 v[44:47], v[116:119], v[172:175], v[44:47]
  s_mov_b32 s51, s52
  v_mfma_f32_16x16x32_bf16 v[68:71], v[120:123], v[172:175], v[68:71]
  s_sub_u32 s53, s53, 1
  v_mfma_f32_16x16x32_bf16 v[92:95], v[124:127], v[172:175], v[92:95]
  s_cmp_lg_u32 s53, 0
  s_cbranch_scc1 L_cl_7
  s_branch L_ov_10
L_hk_8:
  s_lshl_b32 s59, s75, 7
  s_sub_u32 s60, 2097152, s59
  s_add_u32 s44, s8, s59
  s_addc_u32 s45, s9, 0
  s_mov_b32 s46, s60
  s_mov_b32 s47, 0x00020000
  s_mul_i32 s59, s74, 8
  s_mul_i32 s60, s48, 2
  s_add_u32 s59, s59, s60
  v_lshrrev_b32 v240, 3, v255
  v_and_b32 v241, 7, v255
  v_bfe_u32 v242, v255, 4, 1
  v_lshlrev_b32 v240, 11, v240
  v_lshlrev_b32 v243, 1, v242
  v_xor_b32 v243, v243, v241
  v_lshl_add_u32 v243, v243, 4, v240
  v_or_b32 v242, 2, v242
  v_lshlrev_b32 v242, 1, v242
  v_xor_b32 v242, v242, v241
  v_lshl_add_u32 v242, v242, 4, v240
  s_and_b32 s60, s59, 1
  s_cmp_eq_u32 s60, 0
  s_cselect_b64 vcc, -1, 0
  s_nop 1
  v_cndmask_b32 v244, v242, v243, vcc
  v_cndmask_b32 v245, v243, v242, vcc
  s_lshl_b32 s60, s59, 14
  buffer_load_dwordx4 v[200:203], v244, s[44:47], s60 offen
  s_add_u32 s60, s60, 16384
  buffer_load_dwordx4 v[204:207], v245, s[44:47], s60 offen
  s_mov_b32 s95, -1
  s_branch L_hb_9
L_hn_11:
L_ov_10:
  s_waitcnt lgkmcnt(0)
  s_nop 7
  s_nop 1
  s_branch L_a_join_6
L_a_l1_5:
  s_mov_b32 s60, 34078720
  s_lshl_b32 s59, s72, 10
  s_add_u32 s60, s60, s59
  s_add_u32 s40, s20, s60
  s_addc_u32 s41, s21, 0
  s_mov_b32 s42, 262144
  s_mov_b32 s43, 0x00020000
  s_lshl_b32 s59, s73, 14
  s_add_u32 s44, s20, 34603008
  s_addc_u32 s45, s21, 0
  s_add_u32 s44, s44, s59
  s_addc_u32 s45, s45, 0
  s_mov_b32 s46, 16384
  s_mov_b32 s47, 0x00020000
  s_lshl_b32 s52, s48, 6
  v_add_u32 v243, s52, v255
  v_lshlrev_b32 v244, 2, v243
  buffer_load_dword v128, v244, s[44:47], 0 offen offset:0 sc1
  buffer_load_dword v129, v244, s[44:47], 0 offen offset:1024 sc1
  buffer_load_dword v130, v244, s[44:47], 0 offen offset:2048 sc1
  buffer_load_dword v131, v244, s[44:47], 0 offen offset:3072 sc1
  s_mov_b32 s59, 4096
  buffer_load_dword v132, v244, s[44:47], s59 offen offset:0 sc1
  buffer_load_dword v133, v244, s[44:47], s59 offen offset:1024 sc1
  buffer_load_dword v134, v244, s[44:47], s59 offen offset:2048 sc1
  buffer_load_dword v135, v244, s[44:47], s59 offen offset:3072 sc1
  s_mov_b32 s59, 8192
  buffer_load_dword v136, v244, s[44:47], s59 offen offset:0 sc1
  buffer_load_dword v137, v244, s[44:47], s59 offen offset:1024 sc1
  buffer_load_dword v138, v244, s[44:47], s59 offen offset:2048 sc1
  buffer_load_dword v139, v244, s[44:47], s59 offen offset:3072 sc1
  s_mov_b32 s59, 12288
  buffer_load_dword v140, v244, s[44:47], s59 offen offset:0 sc1
  buffer_load_dword v141, v244, s[44:47], s59 offen offset:1024 sc1
  buffer_load_dword v142, v244, s[44:47], s59 offen offset:2048 sc1
  buffer_load_dword v143, v244, s[44:47], s59 offen offset:3072 sc1
  v_and_b32 v245, 31, v255
  s_lshl_b32 s52, s48, 5
  v_add_u32 v245, s52, v245
  v_lshrrev_b32 v241, 5, v255
  v_lshlrev_b32 v242, 3, v245
  v_lshl_add_u32 v242, v241, 17, v242
  s_waitcnt vmcnt(0)
  v_pk_add_f32 v[128:129], v[128:129], v[136:137]
  v_pk_add_f32 v[130:131], v[130:131], v[138:139]
  v_pk_add_f32 v[132:133], v[132:133], v[140:141]
  v_pk_add_f32 v[134:135], v[134:135], v[142:143]
  v_pk_add_f32 v[128:129], v[128:129], v[132:133]
  v_pk_add_f32 v[130:131], v[130:131], v[134:135]
  v_pk_add_f32 v[128:129], v[128:129], v[130:131]
  v_add_f32 v128, v128, v129
  v_add_u32 v244, 148480, v244
  ds_write_b32 v244, v128
  s_lshl_b32 s63, s71, 2
  s_add_u32 s63, s63, 0
  v_mov_b32 v246, 152576
  s_mov_b32 s94, 0x1000000
L_fw_12:
  ds_read_b32 v247, v246
  s_waitcnt lgkmcnt(0)
  v_readfirstlane_b32 s52, v247
  s_nop 3
  s_cmp_ge_u32 s52, s63
  s_cbranch_scc1 L_fok_13
  s_sub_u32 s94, s94, 1
  s_cmp_eq_u32 s94, 0
  s_cbranch_scc1 L_fok_13
  s_sleep 1
  s_branch L_fw_12
L_fok_13:
  s_mov_b32 s52, 0
  buffer_load_dwordx2 v[200:201], v242, s[40:43], s52 offen sc1
  s_mov_b32 s52, 16384
  buffer_load_dwordx2 v[202:203], v242, s[40:43], s52 offen sc1
  s_mov_b32 s52, 32768
  buffer_load_dwordx2 v[204:205], v242, s[40:43], s52 offen sc1
  s_mov_b32 s52, 49152
  buffer_load_dwordx2 v[206:207], v242, s[40:43], s52 offen sc1
  s_mov_b32 s52, 65536
  buffer_load_dwordx2 v[208:209], v242, s[40:43], s52 offen sc1
  s_mov_b32 s52, 81920
  buffer_load_dwordx2 v[210:211], v242, s[40:43], s52 offen sc1
  s_mov_b32 s52, 98304
  buffer_load_dwordx2 v[212:213], v242, s[40:43], s52 offen sc1
  s_mov_b32 s52, 114688
  buffer_load_dwordx2 v[214:215], v242, s[40:43], s52 offen sc1
  v_and_b32 v240, 15, v255
  v_add_u32 v240, s61, v240
  v_lshlrev_b32 v240, 5, v240
  v_lshrrev_b32 v241, 5, v255
  v_lshl_add_u32 v240, v241, 12, v240
  v_bfe_u32 v241, v255, 4, 1
  v_lshl_add_u32 v236, v241, 4, v240
  s_mov_b32 s95, 14
  s_mov_b32 s53, 16
  s_mov_b32 s51, 40960
  s_mov_b32 s62, 40960
  s_barrier
  ds_read_b128 v[96:99], v236 offset:0
  ds_read_b128 v[100:103], v236 offset:512
  ds_read_b128 v[104:107], v236 offset:1024
  ds_read_b128 v[108:111], v236 offset:1536
  ds_read_b64_tr_b16 v[128:129], v224 offset:0
  ds_read_b64_tr_b16 v[130:131], v224 offset:512
  ds_read_b64_tr_b16 v[132:133], v225 offset:0
  ds_read_b64_tr_b16 v[134:135], v225 offset:512
  ds_read_b64_tr_b16 v[136:137], v224 offset:8192
  ds_read_b64_tr_b16 v[138:139], v224 offset:8704
  ds_read_b64_tr_b16 v[140:141], v225 offset:8192
  ds_read_b64_tr_b16 v[142:143], v225 offset:8704
  ds_read_b64_tr_b16 v[144:145], v224 offset:16384
  ds_read_b64_tr_b16 v[146:147], v224 offset:16896
  ds_read_b64_tr_b16 v[148:149], v225 offset:16384
  ds_read_b64_tr_b16 v[150:151], v225 offset:16896
  .p2align 3
L_cl_14:
  s_waitcnt lgkmcnt(0)
  v_mfma_f32_16x16x32_bf16 v[0:3], v[128:131], v[96:99], v[0:3]
  ds_read_b128 v[112:115], v236 offset:8192
  v_mfma_f32_16x16x32_bf16 v[24:27], v[128:131], v[100:103], v[24:27]
  ds_read_b128 v[116:119], v236 offset:8704
  v_mfma_f32_16x16x32_bf16 v[48:51], v[128:131], v[104:107], v[48:51]
  ds_read_b128 v[120:123], v236 offset:9216
  v_mfma_f32_16x16x32_bf16 v[72:75], v[128:131], v[108:111], v[72:75]
  ds_read_b128 v[124:127], v236 offset:9728
  v_mfma_f32_16x16x32_bf16 v[4:7], v[132:135], v[96:99], v[4:7]
  ds_read_b64_tr_b16 v[152:153], v224 offset:4096
  v_mfma_f32_16x16x32_bf16 v[28:31], v[132:135], v[100:103], v[28:31]
  ds_read_b64_tr_b16 v[154:155], v224 offset:4608
  v_mfma_f32_16x16x32_bf16 v[52:55], v[132:135], v[104:107], v[52:55]
  ds_read_b64_tr_b16 v[156:157], v225 offset:4096
  v_mfma_f32_16x16x32_bf16 v[76:79], v[132:135], v[108:111], v[76:79]
  ds_read_b64_tr_b16 v[158:159], v225 offset:4608
  v_mfma_f32_16x16x32_bf16 v[8:11], v[96:99], v[136:139], v[8:11]
  ds_read_b64_tr_b16 v[160:161], v224 offset:12288
  v_mfma_f32_16x16x32_bf16 v[32:35], v[100:103], v[136:139], v[32:35]
  ds_read_b64_tr_b16 v[162:163], v224 offset:12800
  v_mfma_f32_16x16x32_bf16 v[56:59], v[104:107], v[136:139], v[56:59]
  ds_read_b64_tr_b16 v[164:165], v225 offset:12288
  v_mfma_f32_16x16x32_bf16 v[80:83], v[108:111], v[136:139], v[80:83]
  ds_read_b64_tr_b16 v[166:167], v225 offset:12800
  v_mfma_f32_16x16x32_bf16 v[12:15], v[96:99], v[140:143], v[12:15]
  ds_read_b64_tr_b16 v[168:169], v224 offset:20480
  v_mfma_f32_16x16x32_bf16 v[36:39], v[100:103], v[140:143], v[36:39]
  ds_read_b64_tr_b16 v[170:171], v224 offset:20992
  v_mfma_f32_16x16x32_bf16 v[60:63], v[104:107], v[140:143], v[60:63]
  ds_read_b64_tr_b16 v[172:173], v225 offset:20480
  v_mfma_f32_16x16x32_bf16 v[84:87], v[108:111], v[140:143], v[84:87]
  ds_read_b64_tr_b16 v[174:175], v225 offset:20992
  v_mfma_f32_16x16x32_bf16 v[16:19], v[96:99], v[144:147], v[16:19]
  v_add_u32 v236, s62, v236
  v_mfma_f32_16x16x32_bf16 v[40:43], v[100:103], v[144:147], v[40:43]
  v_add_u32 v224, s62, v224
  v_mfma_f32_16x16x32_bf16 v[64:67], v[104:107], v[144:147], v[64:67]
  v_add_u32 v225, s62, v225
  v_mfma_f32_16x16x32_bf16 v[88:91], v[108:111], v[144:147], v[88:91]
  s_cmp_eq_u32 s95, s53
  v_mfma_f32_16x16x32_bf16 v[20:23], v[96:99], v[148:151], v[20:23]
  s_cbranch_scc1 L_hk_15
L_hb_16:
  v_mfma_f32_16x16x32_bf16 v[44:47], v[100:103], v[148:151], v[44:47]
  v_mfma_f32_16x16x32_bf16 v[68:71], v[104:107], v[148:151], v[68:71]
  v_mfma_f32_16x16x32_bf16 v[92:95], v[108:111], v[148:151], v[92:95]
  s_waitcnt lgkmcnt(0)
  v_mfma_f32_16x16x32_bf16 v[0:3], v[152:155], v[112:115], v[0:3]
  s_barrier
  v_mfma_f32_16x16x32_bf16 v[24:27], v[152:155], v[116:119], v[24:27]
  ds_read_b128 v[96:99], v236 offset:0
  v_mfma_f32_16x16x32_bf16 v[48:51], v[152:155], v[120:123], v[48:51]
  ds_read_b128 v[100:103], v236 offset:512
  v_mfma_f32_16x16x32_bf16 v[72:75], v[152:155], v[124:127], v[72:75]
  ds_read_b128 v[104:107], v236 offset:1024
  v_mfma_f32_16x16x32_bf16 v[4:7], v[156:159], v[112:115], v[4:7]
  ds_read_b128 v[108:111], v236 offset:1536
  v_mfma_f32_16x16x32_bf16 v[28:31], v[156:159], v[116:119], v[28:31]
  ds_read_b64_tr_b16 v[128:129], v224 offset:0
  v_mfma_f32_16x16x32_bf16 v[52:55], v[156:159], v[120:123], v[52:55]
  ds_read_b64_tr_b16 v[130:131], v224 offset:512
  v_mfma_f32_16x16x32_bf16 v[76:79], v[156:159], v[124:127], v[76:79]
  ds_read_b64_tr_b16 v[132:133], v225 offset:0
  v_mfma_f32_16x16x32_bf16 v[8:11], v[112:115], v[160:163], v[8:11]
  ds_read_b64_tr_b16 v[134:135], v225 offset:512
  v_mfma_f32_16x16x32_bf16 v[32:35], v[116:119], v[160:163], v[32:35]
  ds_read_b64_tr_b16 v[136:137], v224 offset:8192
  v_mfma_f32_16x16x32_bf16 v[56:59], v[120:123], v[160:163], v[56:59]
  ds_read_b64_tr_b16 v[138:139], v224 offset:8704
  v_mfma_f32_16x16x32_bf16 v[80:83], v[124:127], v[160:163], v[80:83]
  ds_read_b64_tr_b16 v[140:141], v225 offset:8192
  v_mfma_f32_16x16x32_bf16 v[12:15], v[112:115], v[164:167], v[12:15]
  ds_read_b64_tr_b16 v[142:143], v225 offset:8704
  v_mfma_f32_16x16x32_bf16 v[36:39], v[116:119], v[164:167], v[36:39]
  ds_read_b64_tr_b16 v[144:145], v224 offset:16384
  v_mfma_f32_16x16x32_bf16 v[60:63], v[120:123], v[164:167], v[60:63]
  ds_read_b64_tr_b16 v[146:147], v224 offset:16896
  v_mfma_f32_16x16x32_bf16 v[84:87], v[124:127], v[164:167], v[84:87]
  ds_read_b64_tr_b16 v[148:149], v225 offset:16384
  v_mfma_f32_16x16x32_bf16 v[16:19], v[112:115], v[168:171], v[16:19]
  ds_read_b64_tr_b16 v[150:151], v225 offset:16896
  v_mfma_f32_16x16x32_bf16 v[40:43], v[116:119], v[168:171], v[40:43]
  s_add_u32 s52, s51, 40960
  v_mfma_f32_16x16x32_bf16 v[64:67], v[120:123], v[168:171], v[64:67]
  s_cmp_eq_u32 s52, 122880
  v_mfma_f32_16x16x32_bf16 v[88:91], v[124:127], v[168:171], v[88:91]
  s_cselect_b32 s52, 0, s52
  v_mfma_f32_16x16x32_bf16 v[20:23], v[112:115], v[172:175], v[20:23]
  s_sub_u32 s62, s52, s51
  v_mfma_f32_16x16x32_bf16 v[44:47], v[116:119], v[172:175], v[44:47]
  s_mov_b32 s51, s52
  v_mfma_f32_16x16x32_bf16 v[68:71], v[120:123], v[172:175], v[68:71]
  s_sub_u32 s53, s53, 1
  v_mfma_f32_16x16x32_bf16 v[92:95], v[124:127], v[172:175], v[92:95]
  s_cmp_lg_u32 s53, 0
  s_cbranch_scc1 L_cl_14
  s_branch L_ov_17
L_hk_15:
  s_waitcnt vmcnt(0)
  v_pk_add_f32 v[200:201], v[200:201], v[208:209]
  v_pk_add_f32 v[202:203], v[202:203], v[210:211]
  v_pk_add_f32 v[204:205], v[204:205], v[212:213]
  v_pk_add_f32 v[206:207], v[206:207], v[214:215]
  v_pk_add_f32 v[200:201], v[200:201], v[204:205]
  v_pk_add_f32 v[202:203], v[202:203], v[206:207]
  v_pk_add_f32 v[200:201], v[200:201], v[202:203]
  v_and_b32 v245, 31, v255
  s_lshl_b32 s52, s48, 5
  v_add_u32 v245, s52, v245
  v_mov_b32 v202, v200
  v_mov_b32 v203, v201
  v_lshlrev_b32 v245, 2, v245
  v_add_u32 v245, 147456, v245
  v_permlane32_swap_b32 v200, v202
  v_permlane32_swap_b32 v201, v203
  s_nop 1
  v_add_f32 v200, v200, v202
  v_add_f32 v201, v201, v203
  v_mul_f32 v200, 0x3a800000, v200
  v_mul_f32 v201, 0x3a800000, v201
  v_fma_f32 v201, -v200, v200, v201
  v_max_f32 v201, 0, v201
  v_add_f32 v201, 0x3727c5ac, v201
  v_rsq_f32 v201, v201
  v_sub_f32 v200, 0, v200
  ds_write_b32 v245, v200
  ds_write_b32 v245, v201 offset:512
  s_mov_b32 s95, -1
  s_branch L_hb_16
L_hn_18:
L_ov_17:
  s_waitcnt lgkmcnt(0)
  s_nop 7
  s_nop 1
L_a_join_6:
  ds_read_b128 v[180:183], v229
  ds_read_b128 v[184:187], v229 offset:512
  ds_read_b32 v104, v232 offset:256
  ds_read_b32 v105, v232 offset:320
  ds_read_b32 v106, v232 offset:512
  ds_read_b32 v107, v232 offset:576
  ds_read_b128 v[96:99], v231
  ds_read_b128 v[100:103], v231 offset:64
  ds_read_b32 v108, v233 offset:0
  ds_read_b32 v109, v233 offset:512
  ds_read_b32 v112, v233 offset:64
  ds_read_b32 v113, v233 offset:576
  ds_read_b32 v116, v233 offset:128
  ds_read_b32 v117, v233 offset:640
  ds_read_b32 v120, v233 offset:192
  ds_read_b32 v121, v233 offset:704
  s_cmp_lg_u32 s71, 0
  s_cbranch_scc1 L_nowoc_19
  s_waitcnt vmcnt(0)
  s_mul_i32 s59, s75, 131072
  s_mul_i32 s60, s74, 8192
  s_add_u32 s59, s59, s60
  s_mul_i32 s60, s48, 2048
  s_add_u32 s59, s59, s60
  s_add_u32 s44, s20, 50331648
  s_addc_u32 s45, s21, 0
  s_add_u32 s44, s44, s59
  s_addc_u32 s45, s45, 0
  s_mov_b32 s46, 2048
  s_mov_b32 s47, 0x00020000
  v_lshlrev_b32 v240, 4, v255
  buffer_store_dwordx4 v[200:203], v240, s[44:47], 0 offen offset:0 sc1
  buffer_store_dwordx4 v[204:207], v240, s[44:47], 0 offen offset:1024 sc1
L_nowoc_19:
  s_waitcnt lgkmcnt(0)
  ds_read_b128 v[192:195], v229 offset:64
  ds_read_b128 v[196:199], v229 offset:576
  v_mul_f32 v188, 0x3fb8aa3b, v184
  v_mul_f32 v189, 0x3fb8aa3b, v185
  v_mul_f32 v190, 0x3fb8aa3b, v186
  v_mul_f32 v191, 0x3fb8aa3b, v187
  v_pk_fma_f32 v[124:125], v[104:105], v[180:181], v[8:9] op_sel:[0,0,0] op_sel_hi:[0,1,1]
  v_pk_fma_f32 v[128:129], v[104:105], v[182:183], v[10:11] op_sel:[0,0,0] op_sel_hi:[0,1,1]
  v_pk_fma_f32 v[132:133], v[104:105], v[180:181], v[12:13] op_sel:[1,0,0] op_sel_hi:[1,1,1]
  v_pk_fma_f32 v[136:137], v[104:105], v[182:183], v[14:15] op_sel:[1,0,0] op_sel_hi:[1,1,1]
  v_pk_fma_f32 v[140:141], v[106:107], v[180:181], v[16:17] op_sel:[0,0,0] op_sel_hi:[0,1,1]
  v_pk_fma_f32 v[142:143], v[106:107], v[182:183], v[18:19] op_sel:[0,0,0] op_sel_hi:[0,1,1]
  v_pk_fma_f32 v[144:145], v[106:107], v[180:181], v[20:21] op_sel:[1,0,0] op_sel_hi:[1,1,1]
  v_pk_fma_f32 v[146:147], v[106:107], v[182:183], v[22:23] op_sel:[1,0,0] op_sel_hi:[1,1,1]
  v_pk_mul_f32 v[126:127], v[124:125], v[188:189]
  v_pk_mul_f32 v[130:131], v[128:129], v[190:191]
  v_pk_mul_f32 v[134:135], v[132:133], v[188:189]
  v_pk_mul_f32 v[138:139], v[136:137], v[190:191]
  v_exp_f32 v126, v126 clamp
  v_exp_f32 v130, v130 clamp
  v_exp_f32 v134, v134 clamp
  v_exp_f32 v138, v138 clamp
  v_exp_f32 v127, v127 clamp
  v_exp_f32 v131, v131 clamp
  v_exp_f32 v135, v135 clamp
  v_exp_f32 v139, v139 clamp
  v_pk_mul_f32 v[140:141], v[140:141], v[184:185]
  v_pk_mul_f32 v[142:143], v[142:143], v[186:187]
  v_pk_mul_f32 v[144:145], v[144:145], v[184:185]
  v_pk_mul_f32 v[146:147], v[146:147], v[186:187]
  v_pk_fma_f32 v[124:125], v[124:125], v[184:185], v[226:227] op_sel_hi:[1,1,0]
  v_pk_fma_f32 v[128:129], v[128:129], v[186:187], v[226:227] op_sel_hi:[1,1,0]
  v_pk_fma_f32 v[132:133], v[132:133], v[184:185], v[226:227] op_sel_hi:[1,1,0]
  v_pk_fma_f32 v[136:137], v[136:137], v[186:187], v[226:227] op_sel_hi:[1,1,0]
  v_max_f32 v124, v226, v124
  v_max_f32 v128, v226, v128
  v_max_f32 v132, v226, v132
  v_max_f32 v136, v226, v136
  v_max_f32 v125, v226, v125
  v_max_f32 v129, v226, v129
  v_max_f32 v133, v226, v133
  v_max_f32 v137, v226, v137
  v_cvt_pk_bf16_f32 v164, v140, v141
  v_cvt_pk_bf16_f32 v165, v142, v143
  v_cvt_pk_bf16_f32 v172, v144, v145
  v_cvt_pk_bf16_f32 v173, v146, v147
  v_pk_add_f32 v[124:125], v[124:125], v[126:127]
  v_pk_add_f32 v[128:129], v[128:129], v[130:131]
  v_pk_add_f32 v[132:133], v[132:133], v[134:135]
  v_pk_add_f32 v[136:137], v[136:137], v[138:139]
  v_cvt_pk_bf16_f32 v148, v124, v125
  v_cvt_pk_bf16_f32 v149, v128, v129
  v_cvt_pk_bf16_f32 v156, v132, v133
  v_cvt_pk_bf16_f32 v157, v136, v137
  s_waitcnt lgkmcnt(0)
  ds_read_b128 v[180:183], v229 offset:128
  ds_read_b128 v[184:187], v229 offset:640
  v_mul_f32 v200, 0x3fb8aa3b, v196
  v_mul_f32 v201, 0x3fb8aa3b, v197
  v_mul_f32 v202, 0x3fb8aa3b, v198
  v_mul_f32 v203, 0x3fb8aa3b, v199
  v_pk_fma_f32 v[124:125], v[104:105], v[192:193], v[32:33] op_sel:[0,0,0] op_sel_hi:[0,1,1]
  v_pk_fma_f32 v[128:129], v[104:105], v[194:195], v[34:35] op_sel:[0,0,0] op_sel_hi:[0,1,1]
  v_pk_fma_f32 v[132:133], v[104:105], v[192:193], v[36:37] op_sel:[1,0,0] op_sel_hi:[1,1,1]
  v_pk_fma_f32 v[136:137], v[104:105], v[194:195], v[38:39] op_sel:[1,0,0] op_sel_hi:[1,1,1]
  v_pk_fma_f32 v[140:141], v[106:107], v[192:193], v[40:41] op_sel:[0,0,0] op_sel_hi:[0,1,1]
  v_pk_fma_f32 v[142:143], v[106:107], v[194:195], v[42:43] op_sel:[0,0,0] op_sel_hi:[0,1,1]
  v_pk_fma_f32 v[144:145], v[106:107], v[192:193], v[44:45] op_sel:[1,0,0] op_sel_hi:[1,1,1]
  v_pk_fma_f32 v[146:147], v[106:107], v[194:195], v[46:47] op_sel:[1,0,0] op_sel_hi:[1,1,1]
  v_pk_mul_f32 v[126:127], v[124:125], v[200:201]
  v_pk_mul_f32 v[130:131], v[128:129], v[202:203]
  v_pk_mul_f32 v[134:135], v[132:133], v[200:201]
  v_pk_mul_f32 v[138:139], v[136:137], v[202:203]
  v_exp_f32 v126, v126 clamp
  v_exp_f32 v130, v130 clamp
  v_exp_f32 v134, v134 clamp
  v_exp_f32 v138, v138 clamp
  v_exp_f32 v127, v127 clamp
  v_exp_f32 v131, v131 clamp
  v_exp_f32 v135, v135 clamp
  v_exp_f32 v139, v139 clamp
  v_pk_mul_f32 v[140:141], v[140:141], v[196:197]
  v_pk_mul_f32 v[142:143], v[142:143], v[198:199]
  v_pk_mul_f32 v[144:145], v[144:145], v[196:197]
  v_pk_mul_f32 v[146:147], v[146:147], v[198:199]
  v_pk_fma_f32 v[124:125], v[124:125], v[196:197], v[226:227] op_sel_hi:[1,1,0]
  v_pk_fma_f32 v[128:129], v[128:129], v[198:199], v[226:227] op_sel_hi:[1,1,0]
  v_pk_fma_f32 v[132:133], v[132:133], v[196:197], v[226:227] op_sel_hi:[1,1,0]
  v_pk_fma_f32 v[136:137], v[136:137], v[198:199], v[226:227] op_sel_hi:[1,1,0]
  v_max_f32 v124, v226, v124
  v_max_f32 v128, v226, v128
  v_max_f32 v132, v226, v132
  v_max_f32 v136, v226, v136
  v_max_f32 v125, v226, v125
  v_max_f32 v129, v226, v129
  v_max_f32 v133, v226, v133
  v_max_f32 v137, v226, v137
  v_cvt_pk_bf16_f32 v166, v140, v141
  v_cvt_pk_bf16_f32 v167, v142, v143
  v_cvt_pk_bf16_f32 v174, v144, v145
  v_cvt_pk_bf16_f32 v175, v146, v147
  v_pk_add_f32 v[124:125], v[124:125], v[126:127]
  v_pk_add_f32 v[128:129], v[128:129], v[130:131]
  v_pk_add_f32 v[132:133], v[132:133], v[134:135]
  v_pk_add_f32 v[136:137], v[136:137], v[138:139]
  v_cvt_pk_bf16_f32 v150, v124, v125
  v_cvt_pk_bf16_f32 v151, v128, v129
  v_cvt_pk_bf16_f32 v158, v132, v133
  v_cvt_pk_bf16_f32 v159, v136, v137
  s_waitcnt lgkmcnt(0)
  ds_read_b128 v[192:195], v229 offset:192
  ds_read_b128 v[196:199], v229 offset:704
  v_mul_f32 v188, 0x3fb8aa3b, v184
  v_mul_f32 v189, 0x3fb8aa3b, v185
  v_mul_f32 v190, 0x3fb8aa3b, v186
  v_mul_f32 v191, 0x3fb8aa3b, v187
  v_pk_fma_f32 v[124:125], v[104:105], v[180:181], v[56:57] op_sel:[0,0,0] op_sel_hi:[0,1,1]
  v_pk_fma_f32 v[128:129], v[104:105], v[182:183], v[58:59] op_sel:[0,0,0] op_sel_hi:[0,1,1]
  v_pk_fma_f32 v[132:133], v[104:105], v[180:181], v[60:61] op_sel:[1,0,0] op_sel_hi:[1,1,1]
  v_pk_fma_f32 v[136:137], v[104:105], v[182:183], v[62:63] op_sel:[1,0,0] op_sel_hi:[1,1,1]
  v_pk_fma_f32 v[140:141], v[106:107], v[180:181], v[64:65] op_sel:[0,0,0] op_sel_hi:[0,1,1]
  v_pk_fma_f32 v[142:143], v[106:107], v[182:183], v[66:67] op_sel:[0,0,0] op_sel_hi:[0,1,1]
  v_pk_fma_f32 v[144:145], v[106:107], v[180:181], v[68:69] op_sel:[1,0,0] op_sel_hi:[1,1,1]
  v_pk_fma_f32 v[146:147], v[106:107], v[182:183], v[70:71] op_sel:[1,0,0] op_sel_hi:[1,1,1]
  v_pk_mul_f32 v[126:127], v[124:125], v[188:189]
  v_pk_mul_f32 v[130:131], v[128:129], v[190:191]
  v_pk_mul_f32 v[134:135], v[132:133], v[188:189]
  v_pk_mul_f32 v[138:139], v[136:137], v[190:191]
  v_exp_f32 v126, v126 clamp
  v_exp_f32 v130, v130 clamp
  v_exp_f32 v134, v134 clamp
  v_exp_f32 v138, v138 clamp
  v_exp_f32 v127, v127 clamp
  v_exp_f32 v131, v131 clamp
  v_exp_f32 v135, v135 clamp
  v_exp_f32 v139, v139 clamp
  v_pk_mul_f32 v[140:141], v[140:141], v[184:185]
  v_pk_mul_f32 v[142:143], v[142:143], v[186:187]
  v_pk_mul_f32 v[144:145], v[144:145], v[184:185]
  v_pk_mul_f32 v[146:147], v[146:147], v[186:187]
  v_pk_fma_f32 v[124:125], v[124:125], v[184:185], v[226:227] op_sel_hi:[1,1,0]
  v_pk_fma_f32 v[128:129], v[128:129], v[186:187], v[226:227] op_sel_hi:[1,1,0]
  v_pk_fma_f32 v[132:133], v[132:133], v[184:185], v[226:227] op_sel_hi:[1,1,0]
  v_pk_fma_f32 v[136:137], v[136:137], v[186:187], v[226:227] op_sel_hi:[1,1,0]
  v_max_f32 v124, v226, v124
  v_max_f32 v128, v226, v128
  v_max_f32 v132, v226, v132
  v_max_f32 v136, v226, v136
  v_max_f32 v125, v226, v125
  v_max_f32 v129, v226, v129
  v_max_f32 v133, v226, v133
  v_max_f32 v137, v226, v137
  v_cvt_pk_bf16_f32 v168, v140, v141
  v_cvt_pk_bf16_f32 v169, v142, v143
  v_cvt_pk_bf16_f32 v176, v144, v145
  v_cvt_pk_bf16_f32 v177, v146, v147
  v_pk_add_f32 v[124:125], v[124:125], v[126:127]
  v_pk_add_f32 v[128:129], v[128:129], v[130:131]
  v_pk_add_f32 v[132:133], v[132:133], v[134:135]
  v_pk_add_f32 v[136:137], v[136:137], v[138:139]
  v_cvt_pk_bf16_f32 v152, v124, v125
  v_cvt_pk_bf16_f32 v153, v128, v129
  v_cvt_pk_bf16_f32 v160, v132, v133
  v_cvt_pk_bf16_f32 v161, v136, v137
  s_waitcnt lgkmcnt(0)
  v_mul_f32 v200, 0x3fb8aa3b, v196
  v_mul_f32 v201, 0x3fb8aa3b, v197
  v_mul_f32 v202, 0x3fb8aa3b, v198
  v_mul_f32 v203, 0x3fb8aa3b, v199
  v_pk_fma_f32 v[124:125], v[104:105], v[192:193], v[80:81] op_sel:[0,0,0] op_sel_hi:[0,1,1]
  v_pk_fma_f32 v[128:129], v[104:105], v[194:195], v[82:83] op_sel:[0,0,0] op_sel_hi:[0,1,1]
  v_pk_fma_f32 v[132:133], v[104:105], v[192:193], v[84:85] op_sel:[1,0,0] op_sel_hi:[1,1,1]
  v_pk_fma_f32 v[136:137], v[104:105], v[194:195], v[86:87] op_sel:[1,0,0] op_sel_hi:[1,1,1]
  v_pk_fma_f32 v[140:141], v[106:107], v[192:193], v[88:89] op_sel:[0,0,0] op_sel_hi:[0,1,1]
  v_pk_fma_f32 v[142:143], v[106:107], v[194:195], v[90:91] op_sel:[0,0,0] op_sel_hi:[0,1,1]
  v_pk_fma_f32 v[144:145], v[106:107], v[192:193], v[92:93] op_sel:[1,0,0] op_sel_hi:[1,1,1]
  v_pk_fma_f32 v[146:147], v[106:107], v[194:195], v[94:95] op_sel:[1,0,0] op_sel_hi:[1,1,1]
  v_pk_mul_f32 v[126:127], v[124:125], v[200:201]
  v_pk_mul_f32 v[130:131], v[128:129], v[202:203]
  v_pk_mul_f32 v[134:135], v[132:133], v[200:201]
  v_pk_mul_f32 v[138:139], v[136:137], v[202:203]
  v_exp_f32 v126, v126 clamp
  v_exp_f32 v130, v130 clamp
  v_exp_f32 v134, v134 clamp
  v_exp_f32 v138, v138 clamp
  v_exp_f32 v127, v127 clamp
  v_exp_f32 v131, v131 clamp
  v_exp_f32 v135, v135 clamp
  v_exp_f32 v139, v139 clamp
  v_pk_mul_f32 v[140:141], v[140:141], v[196:197]
  v_pk_mul_f32 v[142:143], v[142:143], v[198:199]
  v_pk_mul_f32 v[144:145], v[144:145], v[196:197]
  v_pk_mul_f32 v[146:147], v[146:147], v[198:199]
  v_pk_fma_f32 v[124:125], v[124:125], v[196:197], v[226:227] op_sel_hi:[1,1,0]
  v_pk_fma_f32 v[128:129], v[128:129], v[198:199], v[226:227] op_sel_hi:[1,1,0]
  v_pk_fma_f32 v[132:133], v[132:133], v[196:197], v[226:227] op_sel_hi:[1,1,0]
  v_pk_fma_f32 v[136:137], v[136:137], v[198:199], v[226:227] op_sel_hi:[1,1,0]
  v_max_f32 v124, v226, v124
  v_max_f32 v128, v226, v128
  v_max_f32 v132, v226, v132
  v_max_f32 v136, v226, v136
  v_max_f32 v125, v226, v125
  v_max_f32 v129, v226, v129
  v_max_f32 v133, v226, v133
  v_max_f32 v137, v226, v137
  v_cvt_pk_bf16_f32 v170, v140, v141
  v_cvt_pk_bf16_f32 v171, v142, v143
  v_cvt_pk_bf16_f32 v178, v144, v145
  v_cvt_pk_bf16_f32 v179, v146, v147
  v_pk_add_f32 v[124:125], v[124:125], v[126:127]
  v_pk_add_f32 v[128:129], v[128:129], v[130:131]
  v_pk_add_f32 v[132:133], v[132:133], v[134:135]
  v_pk_add_f32 v[136:137], v[136:137], v[138:139]
  v_cvt_pk_bf16_f32 v154, v124, v125
  v_cvt_pk_bf16_f32 v155, v128, v129
  v_cvt_pk_bf16_f32 v162, v132, v133
  v_cvt_pk_bf16_f32 v163, v136, v137
  v_mov_b32 v40, 0x3f803f80
  v_mov_b32 v41, 0x3f803f80
  v_mov_b32 v42, 0x3f803f80
  v_mov_b32 v43, 0x3f803f80
  s_nop 1
  v_mfma_f32_16x16x32_bf16 v[8:11], v[148:151], v[164:167], 0
  v_mfma_f32_16x16x32_bf16 v[12:15], v[156:159], v[164:167], 0
  v_mfma_f32_16x16x32_bf16 v[16:19], v[148:151], v[172:175], 0
  v_mfma_f32_16x16x32_bf16 v[20:23], v[156:159], v[172:175], 0
  v_mfma_f32_16x16x32_bf16 v[32:35], v[148:151], v[40:43], 0
  v_mfma_f32_16x16x32_bf16 v[36:39], v[156:159], v[40:43], 0
  v_mfma_f32_16x16x32_bf16 v[8:11], v[152:155], v[168:171], v[8:11]
  v_mfma_f32_16x16x32_bf16 v[12:15], v[160:163], v[168:171], v[12:15]
  v_mfma_f32_16x16x32_bf16 v[16:19], v[152:155], v[176:179], v[16:19]
  v_mfma_f32_16x16x32_bf16 v[20:23], v[160:163], v[176:179], v[20:23]
  v_mfma_f32_16x16x32_bf16 v[32:35], v[152:155], v[40:43], v[32:35]
  v_mfma_f32_16x16x32_bf16 v[36:39], v[160:163], v[40:43], v[36:39]
  s_nop 7
  s_cmp_eq_u32 s90, 0
  s_cbranch_scc1 L_wr1_20
  ds_write_b128 v234, v[8:11] offset:0
  ds_write_b128 v234, v[12:15] offset:1024
  ds_write_b128 v234, v[16:19] offset:2048
  ds_write_b128 v234, v[20:23] offset:3072
  ds_write_b128 v234, v[32:35] offset:4096
  ds_write_b128 v234, v[36:39] offset:5120
  s_waitcnt lgkmcnt(0)
  s_barrier
  s_branch L_e1done_21
L_wr1_20:
  s_barrier
  ds_read_b128 v[56:59], v234 offset:0
  ds_read_b128 v[60:63], v234 offset:1024
  ds_read_b128 v[64:67], v234 offset:2048
  ds_read_b128 v[68:71], v234 offset:3072
  ds_read_b128 v[80:83], v234 offset:4096
  ds_read_b128 v[84:87], v234 offset:5120
  v_lshrrev_b32 v241, 4, v255
  v_lshlrev_b32 v241, 4, v241
  v_add_u32 v241, 2048, v241
  s_waitcnt lgkmcnt(0)
  v_pk_add_f32 v[8:9], v[8:9], v[56:57]
  v_pk_add_f32 v[10:11], v[10:11], v[58:59]
  v_pk_add_f32 v[12:13], v[12:13], v[60:61]
  v_pk_add_f32 v[14:15], v[14:15], v[62:63]
  v_pk_add_f32 v[16:17], v[16:17], v[64:65]
  v_pk_add_f32 v[18:19], v[18:19], v[66:67]
  v_pk_add_f32 v[20:21], v[20:21], v[68:69]
  v_pk_add_f32 v[22:23], v[22:23], v[70:71]
  v_pk_add_f32 v[32:33], v[32:33], v[80:81]
  v_pk_add_f32 v[34:35], v[34:35], v[82:83]
  v_pk_add_f32 v[36:37], v[36:37], v[84:85]
  v_pk_add_f32 v[38:39], v[38:39], v[86:87]
  v_cvt_pk_bf16_f32 v56, v8, v9
  v_cvt_pk_bf16_f32 v57, v10, v11
  v_cvt_pk_bf16_f32 v58, v12, v13
  v_cvt_pk_bf16_f32 v59, v14, v15
  v_cvt_pk_bf16_f32 v60, v16, v17
  v_cvt_pk_bf16_f32 v61, v18, v19
  v_cvt_pk_bf16_f32 v62, v20, v21
  v_cvt_pk_bf16_f32 v63, v22, v23
  v_cvt_pk_bf16_f32 v64, v32, v33
  v_cvt_pk_bf16_f32 v65, v34, v35
  v_cvt_pk_bf16_f32 v66, v36, v37
  v_cvt_pk_bf16_f32 v67, v38, v39
  buffer_store_dwordx4 v[56:59], v235, s[36:39], 0 offen offset:0 sc1
  buffer_store_dwordx4 v[60:63], v235, s[36:39], 0 offen offset:1024 sc1
  s_mov_b32 exec_lo, 0x00010001
  s_mov_b32 exec_hi, 0x00010001
  buffer_store_dwordx4 v[64:67], v241, s[36:39], 0 offen sc1
  s_mov_b64 exec, -1
  s_waitcnt vmcnt(0)
  v_mov_b32 v240, 0
  v_mov_b32 v241, 1
  s_mov_b64 exec, 1
  buffer_atomic_add v241, v240, s[76:79], s82 offen sc1
  s_mov_b64 exec, -1
L_e1done_21:
  v_mul_f32 v110, 0x3fb8aa3b, v109
  v_mul_f32 v114, 0x3fb8aa3b, v113
  v_mul_f32 v118, 0x3fb8aa3b, v117
  v_mul_f32 v122, 0x3fb8aa3b, v121
  v_pk_fma_f32 v[124:125], v[96:97], v[108:109], v[0:1] op_sel_hi:[1,0,1]
  v_pk_fma_f32 v[128:129], v[98:99], v[108:109], v[2:3] op_sel_hi:[1,0,1]
  v_pk_fma_f32 v[132:133], v[100:101], v[108:109], v[4:5] op_sel_hi:[1,0,1]
  v_pk_fma_f32 v[136:137], v[102:103], v[108:109], v[6:7] op_sel_hi:[1,0,1]
  v_pk_mul_f32 v[126:127], v[124:125], v[110:111] op_sel_hi:[1,0]
  v_pk_mul_f32 v[130:131], v[128:129], v[110:111] op_sel_hi:[1,0]
  v_pk_mul_f32 v[134:135], v[132:133], v[110:111] op_sel_hi:[1,0]
  v_pk_mul_f32 v[138:139], v[136:137], v[110:111] op_sel_hi:[1,0]
  v_exp_f32 v126, v126 clamp
  v_exp_f32 v130, v130 clamp
  v_exp_f32 v134, v134 clamp
  v_exp_f32 v138, v138 clamp
  v_exp_f32 v127, v127 clamp
  v_exp_f32 v131, v131 clamp
  v_exp_f32 v135, v135 clamp
  v_exp_f32 v139, v139 clamp
  v_pk_fma_f32 v[124:125], v[124:125], v[108:109], v[226:227] op_sel:[0,1,0] op_sel_hi:[1,1,0]
  v_pk_fma_f32 v[128:129], v[128:129], v[108:109], v[226:227] op_sel:[0,1,0] op_sel_hi:[1,1,0]
  v_pk_fma_f32 v[132:133], v[132:133], v[108:109], v[226:227] op_sel:[0,1,0] op_sel_hi:[1,1,0]
  v_pk_fma_f32 v[136:137], v[136:137], v[108:109], v[226:227] op_sel:[0,1,0] op_sel_hi:[1,1,0]
  v_max_f32 v124, v226, v124
  v_max_f32 v128, v226, v128
  v_max_f32 v132, v226, v132
  v_max_f32 v136, v226, v136
  v_max_f32 v125, v226, v125
  v_max_f32 v129, v226, v129
  v_max_f32 v133, v226, v133
  v_max_f32 v137, v226, v137
  v_pk_add_f32 v[124:125], v[124:125], v[126:127]
  v_pk_add_f32 v[128:129], v[128:129], v[130:131]
  v_pk_add_f32 v[132:133], v[132:133], v[134:135]
  v_pk_add_f32 v[136:137], v[136:137], v[138:139]
  v_cvt_pk_bf16_f32 v208, v124, v125
  v_cvt_pk_bf16_f32 v209, v128, v129
  v_cvt_pk_bf16_f32 v210, v132, v133
  v_cvt_pk_bf16_f32 v211, v136, v137
  v_pk_fma_f32 v[124:125], v[96:97], v[112:113], v[24:25] op_sel_hi:[1,0,1]
  v_pk_fma_f32 v[128:129], v[98:99], v[112:113], v[26:27] op_sel_hi:[1,0,1]
  v_pk_fma_f32 v[132:133], v[100:101], v[112:113], v[28:29] op_sel_hi:[1,0,1]
  v_pk_fma_f32 v[136:137], v[102:103], v[112:113], v[30:31] op_sel_hi:[1,0,1]
  v_pk_mul_f32 v[126:127], v[124:125], v[114:115] op_sel_hi:[1,0]
  v_pk_mul_f32 v[130:131], v[128:129], v[114:115] op_sel_hi:[1,0]
  v_pk_mul_f32 v[134:135], v[132:133], v[114:115] op_sel_hi:[1,0]
  v_pk_mul_f32 v[138:139], v[136:137], v[114:115] op_sel_hi:[1,0]
  v_exp_f32 v126, v126 clamp
  v_exp_f32 v130, v130 clamp
  v_exp_f32 v134, v134 clamp
  v_exp_f32 v138, v138 clamp
  v_exp_f32 v127, v127 clamp
  v_exp_f32 v131, v131 clamp
  v_exp_f32 v135, v135 clamp
  v_exp_f32 v139, v139 clamp
  v_pk_fma_f32 v[124:125], v[124:125], v[112:113], v[226:227] op_sel:[0,1,0] op_sel_hi:[1,1,0]
  v_pk_fma_f32 v[128:129], v[128:129], v[112:113], v[226:227] op_sel:[0,1,0] op_sel_hi:[1,1,0]
  v_pk_fma_f32 v[132:133], v[132:133], v[112:113], v[226:227] op_sel:[0,1,0] op_sel_hi:[1,1,0]
  v_pk_fma_f32 v[136:137], v[136:137], v[112:113], v[226:227] op_sel:[0,1,0] op_sel_hi:[1,1,0]
  v_max_f32 v124, v226, v124
  v_max_f32 v128, v226, v128
  v_max_f32 v132, v226, v132
  v_max_f32 v136, v226, v136
  v_max_f32 v125, v226, v125
  v_max_f32 v129, v226, v129
  v_max_f32 v133, v226, v133
  v_max_f32 v137, v226, v137
  v_pk_add_f32 v[124:125], v[124:125], v[126:127]
  v_pk_add_f32 v[128:129], v[128:129], v[130:131]
  v_pk_add_f32 v[132:133], v[132:133], v[134:135]
  v_pk_add_f32 v[136:137], v[136:137], v[138:139]
  v_cvt_pk_bf16_f32 v212, v124, v125
  v_cvt_pk_bf16_f32 v213, v128, v129
  v_cvt_pk_bf16_f32 v214, v132, v133
  v_cvt_pk_bf16_f32 v215, v136, v137
  v_pk_fma_f32 v[124:125], v[96:97], v[116:117], v[48:49] op_sel_hi:[1,0,1]
  v_pk_fma_f32 v[128:129], v[98:99], v[116:117], v[50:51] op_sel_hi:[1,0,1]
  v_pk_fma_f32 v[132:133], v[100:101], v[116:117], v[52:53] op_sel_hi:[1,0,1]
  v_pk_fma_f32 v[136:137], v[102:103], v[116:117], v[54:55] op_sel_hi:[1,0,1]
  v_pk_mul_f32 v[126:127], v[124:125], v[118:119] op_sel_hi:[1,0]
  v_pk_mul_f32 v[130:131], v[128:129], v[118:119] op_sel_hi:[1,0]
  v_pk_mul_f32 v[134:135], v[132:133], v[118:119] op_sel_hi:[1,0]
  v_pk_mul_f32 v[138:139], v[136:137], v[118:119] op_sel_hi:[1,0]
  v_exp_f32 v126, v126 clamp
  v_exp_f32 v130, v130 clamp
  v_exp_f32 v134, v134 clamp
  v_exp_f32 v138, v138 clamp
  v_exp_f32 v127, v127 clamp
  v_exp_f32 v131, v131 clamp
  v_exp_f32 v135, v135 clamp
  v_exp_f32 v139, v139 clamp
  v_pk_fma_f32 v[124:125], v[124:125], v[116:117], v[226:227] op_sel:[0,1,0] op_sel_hi:[1,1,0]
  v_pk_fma_f32 v[128:129], v[128:129], v[116:117], v[226:227] op_sel:[0,1,0] op_sel_hi:[1,1,0]
  v_pk_fma_f32 v[132:133], v[132:133], v[116:117], v[226:227] op_sel:[0,1,0] op_sel_hi:[1,1,0]
  v_pk_fma_f32 v[136:137], v[136:137], v[116:117], v[226:227] op_sel:[0,1,0] op_sel_hi:[1,1,0]
  v_max_f32 v124, v226, v124
  v_max_f32 v128, v226, v128
  v_max_f32 v132, v226, v132
  v_max_f32 v136, v226, v136
  v_max_f32 v125, v226, v125
  v_max_f32 v129, v226, v129
  v_max_f32 v133, v226, v133
  v_max_f32 v137, v226, v137
  v_pk_add_f32 v[124:125], v[124:125], v[126:127]
  v_pk_add_f32 v[128:129], v[128:129], v[130:131]
  v_pk_add_f32 v[132:133], v[132:133], v[134:135]
  v_pk_add_f32 v[136:137], v[136:137], v[138:139]
  v_cvt_pk_bf16_f32 v216, v124, v125
  v_cvt_pk_bf16_f32 v217, v128, v129
  v_cvt_pk_bf16_f32 v218, v132, v133
  v_cvt_pk_bf16_f32 v219, v136, v137
  v_pk_fma_f32 v[124:125], v[96:97], v[120:121], v[72:73] op_sel_hi:[1,0,1]
  v_pk_fma_f32 v[128:129], v[98:99], v[120:121], v[74:75] op_sel_hi:[1,0,1]
  v_pk_fma_f32 v[132:133], v[100:101], v[120:121], v[76:77] op_sel_hi:[1,0,1]
  v_pk_fma_f32 v[136:137], v[102:103], v[120:121], v[78:79] op_sel_hi:[1,0,1]
  v_pk_mul_f32 v[126:127], v[124:125], v[122:123] op_sel_hi:[1,0]
  v_pk_mul_f32 v[130:131], v[128:129], v[122:123] op_sel_hi:[1,0]
  v_pk_mul_f32 v[134:135], v[132:133], v[122:123] op_sel_hi:[1,0]
  v_pk_mul_f32 v[138:139], v[136:137], v[122:123] op_sel_hi:[1,0]
  v_exp_f32 v126, v126 clamp
  v_exp_f32 v130, v130 clamp
  v_exp_f32 v134, v134 clamp
  v_exp_f32 v138, v138 clamp
  v_exp_f32 v127, v127 clamp
  v_exp_f32 v131, v131 clamp
  v_exp_f32 v135, v135 clamp
  v_exp_f32 v139, v139 clamp
  v_pk_fma_f32 v[124:125], v[124:125], v[120:121], v[226:227] op_sel:[0,1,0] op_sel_hi:[1,1,0]
  v_pk_fma_f32 v[128:129], v[128:129], v[120:121], v[226:227] op_sel:[0,1,0] op_sel_hi:[1,1,0]
  v_pk_fma_f32 v[132:133], v[132:133], v[120:121], v[226:227] op_sel:[0,1,0] op_sel_hi:[1,1,0]
  v_pk_fma_f32 v[136:137], v[136:137], v[120:121], v[226:227] op_sel:[0,1,0] op_sel_hi:[1,1,0]
  v_max_f32 v124, v226, v124
  v_max_f32 v128, v226, v128
  v_max_f32 v132, v226, v132
  v_max_f32 v136, v226, v136
  v_max_f32 v125, v226, v125
  v_max_f32 v129, v226, v129
  v_max_f32 v133, v226, v133
  v_max_f32 v137, v226, v137
  v_pk_add_f32 v[124:125], v[124:125], v[126:127]
  v_pk_add_f32 v[128:129], v[128:129], v[130:131]
  v_pk_add_f32 v[132:133], v[132:133], v[134:135]
  v_pk_add_f32 v[136:137], v[136:137], v[138:139]
  v_cvt_pk_bf16_f32 v220, v124, v125
  v_cvt_pk_bf16_f32 v221, v128, v129
  v_cvt_pk_bf16_f32 v222, v132, v133
  v_cvt_pk_bf16_f32 v223, v136, v137
  s_cmp_lg_u32 s71, 0
  s_cbranch_scc1 L_nowos_22
  s_waitcnt vmcnt(0)
  s_add_u32 s60, s75, 208
  s_lshl_b32 s60, s60, 7
  v_mov_b32 v240, 0
  v_mov_b32 v241, 1
  s_mov_b64 exec, 1
  buffer_atomic_add v241, v240, s[76:79], s60 offen sc1
  s_mov_b64 exec, -1
L_nowos_22:
  s_cmp_lg_u32 s48, 0
  s_cbranch_scc1 L_nopoll_23
  v_mov_b32 v248, 0
  s_mov_b32 s94, 0x20000
L_poll_24:
  buffer_load_dword v249, v248, s[76:79], s82 offen sc1
  s_waitcnt vmcnt(0)
  v_readfirstlane_b32 s52, v249
  s_nop 3
  s_cmp_ge_u32 s52, 32
  s_cbranch_scc1 L_pok_25
  s_sub_u32 s94, s94, 1
  s_cmp_eq_u32 s94, 0
  s_cbranch_scc1 L_pok_25
  s_sleep 1
  s_branch L_poll_24
L_pok_25:
L_nopoll_23:
  s_barrier
  buffer_load_dwordx4 v[64:67], v235, s[24:27], 0 offen offset:0 sc1
  buffer_load_dwordx4 v[68:71], v235, s[24:27], 0 offen offset:1024 sc1
  buffer_load_dwordx4 v[72:75], v228, s[24:27], 0 offen sc1
  s_mov_b32 s52, 67584
  buffer_load_dwordx4 v[76:79], v235, s[24:27], s52 offen offset:0 sc1
  buffer_load_dwordx4 v[80:83], v235, s[24:27], s52 offen offset:1024 sc1
  buffer_load_dwordx4 v[84:87], v228, s[24:27], s52 offen sc1
  s_mov_b32 s52, 135168
  buffer_load_dwordx4 v[88:91], v235, s[24:27], s52 offen offset:0 sc1
  buffer_load_dwordx4 v[92:95], v235, s[24:27], s52 offen offset:1024 sc1
  buffer_load_dwordx4 v[96:99], v228, s[24:27], s52 offen sc1
  s_mov_b32 s52, 202752
  buffer_load_dwordx4 v[100:103], v235, s[24:27], s52 offen offset:0 sc1
  buffer_load_dwordx4 v[104:107], v235, s[24:27], s52 offen offset:1024 sc1
  buffer_load_dwordx4 v[108:111], v228, s[24:27], s52 offen sc1
  s_mul_i32 s52, s48, 6144
  s_add_u32 s52, s52, 98304
  v_add_u32 v240, s52, v235
  s_waitcnt vmcnt(9)
  v_lshlrev_b32 v32, 16, v64
  v_and_b32 v33, 0xffff0000, v64
  v_lshlrev_b32 v34, 16, v65
  v_and_b32 v35, 0xffff0000, v65
  v_lshlrev_b32 v36, 16, v66
  v_and_b32 v37, 0xffff0000, v66
  v_lshlrev_b32 v38, 16, v67
  v_and_b32 v39, 0xffff0000, v67
  v_lshlrev_b32 v40, 16, v68
  v_and_b32 v41, 0xffff0000, v68
  v_lshlrev_b32 v42, 16, v69
  v_and_b32 v43, 0xffff0000, v69
  v_lshlrev_b32 v44, 16, v70
  v_and_b32 v45, 0xffff0000, v70
  v_lshlrev_b32 v46, 16, v71
  v_and_b32 v47, 0xffff0000, v71
  v_lshlrev_b32 v48, 16, v72
  v_and_b32 v49, 0xffff0000, v72
  v_lshlrev_b32 v50, 16, v73
  v_and_b32 v51, 0xffff0000, v73
  v_lshlrev_b32 v52, 16, v74
  v_and_b32 v53, 0xffff0000, v74
  v_lshlrev_b32 v54, 16, v75
  v_and_b32 v55, 0xffff0000, v75
  s_waitcnt vmcnt(6)
  v_lshlrev_b32 v112, 16, v76
  v_and_b32 v113, 0xffff0000, v76
  v_lshlrev_b32 v114, 16, v77
  v_and_b32 v115, 0xffff0000, v77
  v_lshlrev_b32 v116, 16, v78
  v_and_b32 v117, 0xffff0000, v78
  v_lshlrev_b32 v118, 16, v79
  v_and_b32 v119, 0xffff0000, v79
  v_pk_add_f32 v[32:33], v[32:33], v[112:113]
  v_pk_add_f32 v[34:35], v[34:35], v[114:115]
  v_pk_add_f32 v[36:37], v[36:37], v[116:117]
  v_pk_add_f32 v[38:39], v[38:39], v[118:119]
  v_lshlrev_b32 v112, 16, v80
  v_and_b32 v113, 0xffff0000, v80
  v_lshlrev_b32 v114, 16, v81
  v_and_b32 v115, 0xffff0000, v81
  v_lshlrev_b32 v116, 16, v82
  v_and_b32 v117, 0xffff0000, v82
  v_lshlrev_b32 v118, 16, v83
  v_and_b32 v119, 0xffff0000, v83
  v_pk_add_f32 v[40:41], v[40:41], v[112:113]
  v_pk_add_f32 v[42:43], v[42:43], v[114:115]
  v_pk_add_f32 v[44:45], v[44:45], v[116:117]
  v_pk_add_f32 v[46:47], v[46:47], v[118:119]
  v_lshlrev_b32 v112, 16, v84
  v_and_b32 v113, 0xffff0000, v84
  v_lshlrev_b32 v114, 16, v85
  v_and_b32 v115, 0xffff0000, v85
  v_lshlrev_b32 v116, 16, v86
  v_and_b32 v117, 0xffff0000, v86
  v_lshlrev_b32 v118, 16, v87
  v_and_b32 v119, 0xffff0000, v87
  v_pk_add_f32 v[48:49], v[48:49], v[112:113]
  v_pk_add_f32 v[50:51], v[50:51], v[114:115]
  v_pk_add_f32 v[52:53], v[52:53], v[116:117]
  v_pk_add_f32 v[54:55], v[54:55], v[118:119]
  s_waitcnt vmcnt(3)
  v_lshlrev_b32 v112, 16, v88
  v_and_b32 v113, 0xffff0000, v88
  v_lshlrev_b32 v114, 16, v89
  v_and_b32 v115, 0xffff0000, v89
  v_lshlrev_b32 v116, 16, v90
  v_and_b32 v117, 0xffff0000, v90
  v_lshlrev_b32 v118, 16, v91
  v_and_b32 v119, 0xffff0000, v91
  v_pk_add_f32 v[32:33], v[32:33], v[112:113]
  v_pk_add_f32 v[34:35], v[34:35], v[114:115]
  v_pk_add_f32 v[36:37], v[36:37], v[116:117]
  v_pk_add_f32 v[38:39], v[38:39], v[118:119]
  v_lshlrev_b32 v112, 16, v92
  v_and_b32 v113, 0xffff0000, v92
  v_lshlrev_b32 v114, 16, v93
  v_and_b32 v115, 0xffff0000, v93
  v_lshlrev_b32 v116, 16, v94
  v_and_b32 v117, 0xffff0000, v94
  v_lshlrev_b32 v118, 16, v95
  v_and_b32 v119, 0xffff0000, v95
  v_pk_add_f32 v[40:41], v[40:41], v[112:113]
  v_pk_add_f32 v[42:43], v[42:43], v[114:115]
  v_pk_add_f32 v[44:45], v[44:45], v[116:117]
  v_pk_add_f32 v[46:47], v[46:47], v[118:119]
  v_lshlrev_b32 v112, 16, v96
  v_and_b32 v113, 0xffff0000, v96
  v_lshlrev_b32 v114, 16, v97
  v_and_b32 v115, 0xffff0000, v97
  v_lshlrev_b32 v116, 16, v98
  v_and_b32 v117, 0xffff0000, v98
  v_lshlrev_b32 v118, 16, v99
  v_and_b32 v119, 0xffff0000, v99
  v_pk_add_f32 v[48:49], v[48:49], v[112:113]
  v_pk_add_f32 v[50:51], v[50:51], v[114:115]
  v_pk_add_f32 v[52:53], v[52:53], v[116:117]
  v_pk_add_f32 v[54:55], v[54:55], v[118:119]
  s_waitcnt vmcnt(0)
  v_lshlrev_b32 v112, 16, v100
  v_and_b32 v113, 0xffff0000, v100
  v_lshlrev_b32 v114, 16, v101
  v_and_b32 v115, 0xffff0000, v101
  v_lshlrev_b32 v116, 16, v102
  v_and_b32 v117, 0xffff0000, v102
  v_lshlrev_b32 v118, 16, v103
  v_and_b32 v119, 0xffff0000, v103
  v_pk_add_f32 v[32:33], v[32:33], v[112:113]
  v_pk_add_f32 v[34:35], v[34:35], v[114:115]
  v_pk_add_f32 v[36:37], v[36:37], v[116:117]
  v_pk_add_f32 v[38:39], v[38:39], v[118:119]
  v_lshlrev_b32 v112, 16, v104
  v_and_b32 v113, 0xffff0000, v104
  v_lshlrev_b32 v114, 16, v105
  v_and_b32 v115, 0xffff0000, v105
  v_lshlrev_b32 v116, 16, v106
  v_and_b32 v117, 0xffff0000, v106
  v_lshlrev_b32 v118, 16, v107
  v_and_b32 v119, 0xffff0000, v107
  v_pk_add_f32 v[40:41], v[40:41], v[112:113]
  v_pk_add_f32 v[42:43], v[42:43], v[114:115]
  v_pk_add_f32 v[44:45], v[44:45], v[116:117]
  v_pk_add_f32 v[46:47], v[46:47], v[118:119]
  v_lshlrev_b32 v112, 16, v108
  v_and_b32 v113, 0xffff0000, v108
  v_lshlrev_b32 v114, 16, v109
  v_and_b32 v115, 0xffff0000, v109
  v_lshlrev_b32 v116, 16, v110
  v_and_b32 v117, 0xffff0000, v110
  v_lshlrev_b32 v118, 16, v111
  v_and_b32 v119, 0xffff0000, v111
  v_pk_add_f32 v[48:49], v[48:49], v[112:113]
  v_pk_add_f32 v[50:51], v[50:51], v[114:115]
  v_pk_add_f32 v[52:53], v[52:53], v[116:117]
  v_pk_add_f32 v[54:55], v[54:55], v[118:119]
  ds_write_b128 v240, v[32:35] offset:0
  ds_write_b128 v240, v[36:39] offset:1024
  ds_write_b128 v240, v[40:43] offset:2048
  ds_write_b128 v240, v[44:47] offset:3072
  ds_write_b128 v240, v[48:51] offset:4096
  ds_write_b128 v240, v[52:55] offset:5120
  s_waitcnt lgkmcnt(0)
  s_barrier
  ds_read_b128 v[32:35], v234 offset:0
  ds_read_b128 v[36:39], v234 offset:1024
  ds_read_b128 v[40:43], v234 offset:2048
  ds_read_b128 v[44:47], v234 offset:3072
  ds_read_b128 v[48:51], v234 offset:4096
  ds_read_b128 v[52:55], v234 offset:5120
  ds_read_b128 v[56:59], v234 offset:12288
  ds_read_b128 v[60:63], v234 offset:13312
  ds_read_b128 v[64:67], v234 offset:14336
  ds_read_b128 v[68:71], v234 offset:15360
  ds_read_b128 v[72:75], v234 offset:16384
  ds_read_b128 v[76:79], v234 offset:17408
  ds_read_b128 v[80:83], v234 offset:24576
  ds_read_b128 v[84:87], v234 offset:25600
  ds_read_b128 v[88:91], v234 offset:26624
  ds_read_b128 v[92:95], v234 offset:27648
  ds_read_b128 v[96:99], v234 offset:28672
  ds_read_b128 v[100:103], v234 offset:29696
  ds_read_b128 v[104:107], v234 offset:36864
  ds_read_b128 v[108:111], v234 offset:37888
  ds_read_b128 v[112:115], v234 offset:38912
  ds_read_b128 v[116:119], v234 offset:39936
  ds_read_b128 v[120:123], v234 offset:40960
  ds_read_b128 v[124:127], v234 offset:41984
  s_waitcnt lgkmcnt(12)
  v_pk_add_f32 v[32:33], v[32:33], v[56:57]
  v_pk_add_f32 v[34:35], v[34:35], v[58:59]
  v_pk_add_f32 v[36:37], v[36:37], v[60:61]
  v_pk_add_f32 v[38:39], v[38:39], v[62:63]
  v_pk_add_f32 v[40:41], v[40:41], v[64:65]
  v_pk_add_f32 v[42:43], v[42:43], v[66:67]
  v_pk_add_f32 v[44:45], v[44:45], v[68:69]
  v_pk_add_f32 v[46:47], v[46:47], v[70:71]
  v_pk_add_f32 v[48:49], v[48:49], v[72:73]
  v_pk_add_f32 v[50:51], v[50:51], v[74:75]
  v_pk_add_f32 v[52:53], v[52:53], v[76:77]
  v_pk_add_f32 v[54:55], v[54:55], v[78:79]
  s_waitcnt lgkmcnt(6)
  v_pk_add_f32 v[32:33], v[32:33], v[80:81]
  v_pk_add_f32 v[34:35], v[34:35], v[82:83]
  v_pk_add_f32 v[36:37], v[36:37], v[84:85]
  v_pk_add_f32 v[38:39], v[38:39], v[86:87]
  v_pk_add_f32 v[40:41], v[40:41], v[88:89]
  v_pk_add_f32 v[42:43], v[42:43], v[90:91]
  v_pk_add_f32 v[44:45], v[44:45], v[92:93]
  v_pk_add_f32 v[46:47], v[46:47], v[94:95]
  v_pk_add_f32 v[48:49], v[48:49], v[96:97]
  v_pk_add_f32 v[50:51], v[50:51], v[98:99]
  v_pk_add_f32 v[52:53], v[52:53], v[100:101]
  v_pk_add_f32 v[54:55], v[54:55], v[102:103]
  s_waitcnt lgkmcnt(0)
  v_pk_add_f32 v[32:33], v[32:33], v[104:105]
  v_pk_add_f32 v[34:35], v[34:35], v[106:107]
  v_pk_add_f32 v[36:37], v[36:37], v[108:109]
  v_pk_add_f32 v[38:39], v[38:39], v[110:111]
  v_pk_add_f32 v[40:41], v[40:41], v[112:113]
  v_pk_add_f32 v[42:43], v[42:43], v[114:115]
  v_pk_add_f32 v[44:45], v[44:45], v[116:117]
  v_pk_add_f32 v[46:47], v[46:47], v[118:119]
  v_pk_add_f32 v[48:49], v[48:49], v[120:121]
  v_pk_add_f32 v[50:51], v[50:51], v[122:123]
  v_pk_add_f32 v[52:53], v[52:53], v[124:125]
  v_pk_add_f32 v[54:55], v[54:55], v[126:127]
  v_cvt_pk_bf16_f32 v130, v32, v33
  v_cvt_pk_bf16_f32 v131, v34, v35
  v_cvt_pk_bf16_f32 v132, v36, v37
  v_cvt_pk_bf16_f32 v133, v38, v39
  v_cvt_pk_bf16_f32 v134, v40, v41
  v_cvt_pk_bf16_f32 v135, v42, v43
  v_cvt_pk_bf16_f32 v136, v44, v45
  v_cvt_pk_bf16_f32 v137, v46, v47
  v_cvt_pk_bf16_f32 v138, v48, v49
  v_cvt_pk_bf16_f32 v139, v50, v51
  v_cvt_pk_bf16_f32 v140, v52, v53
  v_cvt_pk_bf16_f32 v141, v54, v55
  s_nop 1
  v_mfma_f32_16x16x32_bf16 v[152:155], v[138:141], v[208:211], 0
  v_mfma_f32_16x16x32_bf16 v[164:167], v[138:141], v[212:215], 0
  v_mfma_f32_16x16x32_bf16 v[176:179], v[138:141], v[216:219], 0
  v_mfma_f32_16x16x32_bf16 v[188:191], v[138:141], v[220:223], 0
  v_mfma_f32_16x16x32_bf16 v[144:147], v[130:133], v[208:211], 0
  v_mfma_f32_16x16x32_bf16 v[156:159], v[130:133], v[212:215], 0
  v_mfma_f32_16x16x32_bf16 v[168:171], v[130:133], v[216:219], 0
  v_mfma_f32_16x16x32_bf16 v[180:183], v[130:133], v[220:223], 0
  v_mfma_f32_16x16x32_bf16 v[148:151], v[134:137], v[208:211], 0
  v_mfma_f32_16x16x32_bf16 v[160:163], v[134:137], v[212:215], 0
  v_mfma_f32_16x16x32_bf16 v[172:175], v[134:137], v[216:219], 0
  v_mfma_f32_16x16x32_bf16 v[184:187], v[134:137], v[220:223], 0
  v_add_f32 v152, 0x358637bd, v152
  v_add_f32 v164, 0x358637bd, v164
  v_add_f32 v176, 0x358637bd, v176
  v_add_f32 v188, 0x358637bd, v188
  v_rcp_f32 v152, v152
  v_rcp_f32 v164, v164
  v_rcp_f32 v176, v176
  v_rcp_f32 v188, v188
  s_nop 3
  v_pk_mul_f32 v[144:145], v[144:145], v[152:153] op_sel_hi:[1,0]
  v_pk_mul_f32 v[146:147], v[146:147], v[152:153] op_sel_hi:[1,0]
  v_pk_mul_f32 v[148:149], v[148:149], v[152:153] op_sel_hi:[1,0]
  v_pk_mul_f32 v[150:151], v[150:151], v[152:153] op_sel_hi:[1,0]
  v_cvt_pk_bf16_f32 v192, v144, v145
  v_cvt_pk_bf16_f32 v193, v146, v147
  v_cvt_pk_bf16_f32 v194, v148, v149
  v_cvt_pk_bf16_f32 v195, v150, v151
  buffer_store_dwordx2 v[192:193], v230, s[32:35], s80 offen offset:0 sc1
  buffer_store_dwordx2 v[194:195], v230, s[32:35], s81 offen offset:0 sc1
  v_pk_mul_f32 v[156:157], v[156:157], v[164:165] op_sel_hi:[1,0]
  v_pk_mul_f32 v[158:159], v[158:159], v[164:165] op_sel_hi:[1,0]
  v_pk_mul_f32 v[160:161], v[160:161], v[164:165] op_sel_hi:[1,0]
  v_pk_mul_f32 v[162:163], v[162:163], v[164:165] op_sel_hi:[1,0]
  v_cvt_pk_bf16_f32 v196, v156, v157
  v_cvt_pk_bf16_f32 v197, v158, v159
  v_cvt_pk_bf16_f32 v198, v160, v161
  v_cvt_pk_bf16_f32 v199, v162, v163
  buffer_store_dwordx2 v[196:197], v230, s[32:35], s80 offen offset:512 sc1
  buffer_store_dwordx2 v[198:199], v230, s[32:35], s81 offen offset:512 sc1
  v_pk_mul_f32 v[168:169], v[168:169], v[176:177] op_sel_hi:[1,0]
  v_pk_mul_f32 v[170:171], v[170:171], v[176:177] op_sel_hi:[1,0]
  v_pk_mul_f32 v[172:173], v[172:173], v[176:177] op_sel_hi:[1,0]
  v_pk_mul_f32 v[174:175], v[174:175], v[176:177] op_sel_hi:[1,0]
  v_cvt_pk_bf16_f32 v200, v168, v169
  v_cvt_pk_bf16_f32 v201, v170, v171
  v_cvt_pk_bf16_f32 v202, v172, v173
  v_cvt_pk_bf16_f32 v203, v174, v175
  buffer_store_dwordx2 v[200:201], v230, s[32:35], s80 offen offset:1024 sc1
  buffer_store_dwordx2 v[202:203], v230, s[32:35], s81 offen offset:1024 sc1
  v_pk_mul_f32 v[180:181], v[180:181], v[188:189] op_sel_hi:[1,0]
  v_pk_mul_f32 v[182:183], v[182:183], v[188:189] op_sel_hi:[1,0]
  v_pk_mul_f32 v[184:185], v[184:185], v[188:189] op_sel_hi:[1,0]
  v_pk_mul_f32 v[186:187], v[186:187], v[188:189] op_sel_hi:[1,0]
  v_cvt_pk_bf16_f32 v204, v180, v181
  v_cvt_pk_bf16_f32 v205, v182, v183
  v_cvt_pk_bf16_f32 v206, v184, v185
  v_cvt_pk_bf16_f32 v207, v186, v187
  buffer_store_dwordx2 v[204:205], v230, s[32:35], s80 offen offset:1536 sc1
  buffer_store_dwordx2 v[206:207], v230, s[32:35], s81 offen offset:1536 sc1
  s_waitcnt vmcnt(0)
  s_barrier
  s_lshl_b32 s61, s48, 5
  v_and_b32 v240, 15, v255
  v_add_u32 v240, s61, v240
  v_lshlrev_b32 v240, 5, v240
  v_lshrrev_b32 v241, 5, v255
  v_lshl_add_u32 v240, v241, 12, v240
  v_bfe_u32 v241, v255, 4, 1
  v_lshl_add_u32 v236, v241, 4, v240
  v_lshrrev_b32 v240, 4, v255
  v_bfe_u32 v241, v255, 2, 2
  v_lshl_add_u32 v239, v240, 3, v241
  v_lshlrev_b32 v239, 7, v239
  v_and_b32 v242, 3, v255
  v_lshl_add_u32 v239, v242, 3, v239
  v_add_u32 v239, 16384, v239
  v_and_b32 v240, 1, v240
  v_lshlrev_b32 v240, 1, v240
  v_lshrrev_b32 v241, 1, v241
  v_or_b32 v238, v240, v241
  v_xor_b32 v240, 0, v238
  v_lshl_add_u32 v232, v240, 5, v239
  v_xor_b32 v240, 1, v238
  v_lshl_add_u32 v233, v240, 5, v239
  v_xor_b32 v240, 2, v238
  v_lshl_add_u32 v234, v240, 5, v239
  v_xor_b32 v240, 3, v238
  v_lshl_add_u32 v235, v240, 5, v239
  v_and_b32 v240, 15, v255
  v_add_u32 v240, s61, v240
  v_lshrrev_b32 v241, 4, v255
  v_lshlrev_b32 v230, 5, v240
  v_lshl_add_u32 v230, v241, 3, v230
  v_lshlrev_b32 v231, 3, v240
  s_lshl_b32 s80, s75, 2
  s_add_u32 s80, s80, 0
  s_lshl_b32 s80, s80, 12
  s_lshl_b32 s81, s75, 2
  s_add_u32 s81, s81, 1
  s_lshl_b32 s81, s81, 12
  s_lshl_b32 s82, s75, 2
  s_add_u32 s82, s82, 2
  s_lshl_b32 s82, s82, 12
  s_lshl_b32 s83, s75, 2
  s_add_u32 s83, s83, 3
  s_lshl_b32 s83, s83, 12
  s_mul_i32 s59, s74, 262144
  s_cmp_eq_u32 s71, 0
  s_cbranch_scc1 L_res0_26
  s_add_u32 s36, s20, 8388608
  s_addc_u32 s37, s21, 0
  s_add_u32 s36, s36, s59
  s_addc_u32 s37, s37, 0
  s_mov_b32 s38, 262144
  s_mov_b32 s39, 0x00020000
  buffer_load_dwordx2 v[96:97], v230, s[36:39], s80 offen offset:0 sc1
  buffer_load_dwordx2 v[98:99], v230, s[36:39], s81 offen offset:0 sc1
  buffer_load_dwordx2 v[100:101], v230, s[36:39], s82 offen offset:0 sc1
  buffer_load_dwordx2 v[102:103], v230, s[36:39], s83 offen offset:0 sc1
  buffer_load_dwordx2 v[104:105], v230, s[36:39], s80 offen offset:512 sc1
  buffer_load_dwordx2 v[106:107], v230, s[36:39], s81 offen offset:512 sc1
  buffer_load_dwordx2 v[108:109], v230, s[36:39], s82 offen offset:512 sc1
  buffer_load_dwordx2 v[110:111], v230, s[36:39], s83 offen offset:512 sc1
  s_branch L_resj_27
L_res0_26:
  s_add_u32 s36, s4, s59
  s_addc_u32 s37, s5, 0
  s_mov_b32 s38, 262144
  s_mov_b32 s39, 0x00020000
  v_lshlrev_b32 v242, 11, v240
  v_lshl_add_u32 v242, v241, 3, v242
  s_lshl_b32 s52, s75, 7
  v_add_u32 v242, s52, v242
  s_mov_b32 s52, 32768
  buffer_load_dwordx2 v[96:97], v242, s[36:39], 0 offen offset:0
  buffer_load_dwordx2 v[98:99], v242, s[36:39], 0 offen offset:32
  buffer_load_dwordx2 v[100:101], v242, s[36:39], 0 offen offset:64
  buffer_load_dwordx2 v[102:103], v242, s[36:39], 0 offen offset:96
  buffer_load_dwordx2 v[104:105], v242, s[36:39], s52 offen offset:0
  buffer_load_dwordx2 v[106:107], v242, s[36:39], s52 offen offset:32
  buffer_load_dwordx2 v[108:109], v242, s[36:39], s52 offen offset:64
  buffer_load_dwordx2 v[110:111], v242, s[36:39], s52 offen offset:96
L_resj_27:
  s_add_u32 s32, s20, 4194304
  s_addc_u32 s33, s21, 0
  s_add_u32 s32, s32, s59
  s_addc_u32 s33, s33, 0
  s_mov_b32 s34, 262144
  s_mov_b32 s35, 0x00020000
  s_mul_i32 s60, s71, 524288
  s_add_u32 s60, s60, 33816576
  s_lshl_b32 s59, s75, 14
  s_add_u32 s60, s60, s59
  s_lshl_b32 s59, s74, 10
  s_add_u32 s60, s60, s59
  s_add_u32 s40, s20, s60
  s_addc_u32 s41, s21, 0
  s_mov_b32 s42, 1024
  s_mov_b32 s43, 0x00020000
  v_mov_b32 v0, 0
  v_mov_b32 v1, 0
  v_mov_b32 v2, 0
  v_mov_b32 v3, 0
  v_mov_b32 v4, 0
  v_mov_b32 v5, 0
  v_mov_b32 v6, 0
  v_mov_b32 v7, 0
  v_mov_b32 v8, 0
  v_mov_b32 v9, 0
  v_mov_b32 v10, 0
  v_mov_b32 v11, 0
  v_mov_b32 v12, 0
  v_mov_b32 v13, 0
  v_mov_b32 v14, 0
  v_mov_b32 v15, 0
  v_mov_b32 v16, 0
  v_mov_b32 v17, 0
  v_mov_b32 v18, 0
  v_mov_b32 v19, 0
  v_mov_b32 v20, 0
  v_mov_b32 v21, 0
  v_mov_b32 v22, 0
  v_mov_b32 v23, 0
  v_mov_b32 v24, 0
  v_mov_b32 v25, 0
  v_mov_b32 v26, 0
  v_mov_b32 v27, 0
  v_mov_b32 v28, 0
  v_mov_b32 v29, 0
  v_mov_b32 v30, 0
  v_mov_b32 v31, 0
  s_mov_b32 s53, 16
  s_mov_b32 s51, 24576
  s_mov_b32 s62, 24576
  s_barrier
  ds_read_b128 v[32:35], v236 offset:0
  ds_read_b128 v[36:39], v236 offset:512
  ds_read_b64_tr_b16 v[48:49], v232 offset:0
  ds_read_b64_tr_b16 v[50:51], v232 offset:512
  ds_read_b64_tr_b16 v[52:53], v233 offset:0
  ds_read_b64_tr_b16 v[54:55], v233 offset:512
  ds_read_b64_tr_b16 v[56:57], v234 offset:0
  ds_read_b64_tr_b16 v[58:59], v234 offset:512
  ds_read_b64_tr_b16 v[60:61], v235 offset:0
  ds_read_b64_tr_b16 v[62:63], v235 offset:512
  .p2align 3
L_cl_28:
  s_waitcnt lgkmcnt(0)
  v_mfma_f32_16x16x32_bf16 v[0:3], v[48:51], v[32:35], v[0:3]
  ds_read_b128 v[40:43], v236 offset:8192
  ds_read_b128 v[44:47], v236 offset:8704
  v_mfma_f32_16x16x32_bf16 v[16:19], v[48:51], v[36:39], v[16:19]
  ds_read_b64_tr_b16 v[64:65], v232 offset:4096
  ds_read_b64_tr_b16 v[66:67], v232 offset:4608
  v_mfma_f32_16x16x32_bf16 v[4:7], v[52:55], v[32:35], v[4:7]
  ds_read_b64_tr_b16 v[68:69], v233 offset:4096
  ds_read_b64_tr_b16 v[70:71], v233 offset:4608
  v_mfma_f32_16x16x32_bf16 v[20:23], v[52:55], v[36:39], v[20:23]
  ds_read_b64_tr_b16 v[72:73], v234 offset:4096
  ds_read_b64_tr_b16 v[74:75], v234 offset:4608
  v_mfma_f32_16x16x32_bf16 v[8:11], v[56:59], v[32:35], v[8:11]
  ds_read_b64_tr_b16 v[76:77], v235 offset:4096
  ds_read_b64_tr_b16 v[78:79], v235 offset:4608
  v_mfma_f32_16x16x32_bf16 v[24:27], v[56:59], v[36:39], v[24:27]
  v_add_u32 v236, s62, v236
  v_add_u32 v232, s62, v232
  v_mfma_f32_16x16x32_bf16 v[12:15], v[60:63], v[32:35], v[12:15]
  v_add_u32 v233, s62, v233
  v_add_u32 v234, s62, v234
  v_mfma_f32_16x16x32_bf16 v[28:31], v[60:63], v[36:39], v[28:31]
  v_add_u32 v235, s62, v235
  s_waitcnt lgkmcnt(0)
  v_mfma_f32_16x16x32_bf16 v[0:3], v[64:67], v[40:43], v[0:3]
  s_barrier
  v_mfma_f32_16x16x32_bf16 v[16:19], v[64:67], v[44:47], v[16:19]
  ds_read_b128 v[32:35], v236 offset:0
  ds_read_b128 v[36:39], v236 offset:512
  v_mfma_f32_16x16x32_bf16 v[4:7], v[68:71], v[40:43], v[4:7]
  ds_read_b64_tr_b16 v[48:49], v232 offset:0
  ds_read_b64_tr_b16 v[50:51], v232 offset:512
  v_mfma_f32_16x16x32_bf16 v[20:23], v[68:71], v[44:47], v[20:23]
  ds_read_b64_tr_b16 v[52:53], v233 offset:0
  ds_read_b64_tr_b16 v[54:55], v233 offset:512
  v_mfma_f32_16x16x32_bf16 v[8:11], v[72:75], v[40:43], v[8:11]
  ds_read_b64_tr_b16 v[56:57], v234 offset:0
  ds_read_b64_tr_b16 v[58:59], v234 offset:512
  v_mfma_f32_16x16x32_bf16 v[24:27], v[72:75], v[44:47], v[24:27]
  ds_read_b64_tr_b16 v[60:61], v235 offset:0
  ds_read_b64_tr_b16 v[62:63], v235 offset:512
  v_mfma_f32_16x16x32_bf16 v[12:15], v[76:79], v[40:43], v[12:15]
  s_add_u32 s52, s51, 24576
  s_cmp_eq_u32 s52, 98304
  v_mfma_f32_16x16x32_bf16 v[28:31], v[76:79], v[44:47], v[28:31]
  s_cselect_b32 s52, 0, s52
  s_sub_u32 s62, s52, s51
  s_mov_b32 s51, s52
  s_sub_u32 s53, s53, 1
  s_cmp_lg_u32 s53, 0
  s_cbranch_scc1 L_cl_28
  s_waitcnt lgkmcnt(0)
  s_nop 7
  s_nop 1
  s_waitcnt vmcnt(0)
  v_lshlrev_b32 v112, 16, v96
  v_and_b32 v113, 0xffff0000, v96
  v_lshlrev_b32 v114, 16, v97
  v_and_b32 v115, 0xffff0000, v97
  v_pk_add_f32 v[0:1], v[0:1], v[112:113]
  v_pk_add_f32 v[2:3], v[2:3], v[114:115]
  v_lshlrev_b32 v116, 16, v98
  v_and_b32 v117, 0xffff0000, v98
  v_lshlrev_b32 v118, 16, v99
  v_and_b32 v119, 0xffff0000, v99
  v_pk_add_f32 v[4:5], v[4:5], v[116:117]
  v_pk_add_f32 v[6:7], v[6:7], v[118:119]
  v_lshlrev_b32 v112, 16, v100
  v_and_b32 v113, 0xffff0000, v100
  v_lshlrev_b32 v114, 16, v101
  v_and_b32 v115, 0xffff0000, v101
  v_pk_add_f32 v[8:9], v[8:9], v[112:113]
  v_pk_add_f32 v[10:11], v[10:11], v[114:115]
  v_lshlrev_b32 v116, 16, v102
  v_and_b32 v117, 0xffff0000, v102
  v_lshlrev_b32 v118, 16, v103
  v_and_b32 v119, 0xffff0000, v103
  v_pk_add_f32 v[12:13], v[12:13], v[116:117]
  v_pk_add_f32 v[14:15], v[14:15], v[118:119]
  v_lshlrev_b32 v112, 16, v104
  v_and_b32 v113, 0xffff0000, v104
  v_lshlrev_b32 v114, 16, v105
  v_and_b32 v115, 0xffff0000, v105
  v_pk_add_f32 v[16:17], v[16:17], v[112:113]
  v_pk_add_f32 v[18:19], v[18:19], v[114:115]
  v_lshlrev_b32 v116, 16, v106
  v_and_b32 v117, 0xffff0000, v106
  v_lshlrev_b32 v118, 16, v107
  v_and_b32 v119, 0xffff0000, v107
  v_pk_add_f32 v[20:21], v[20:21], v[116:117]
  v_pk_add_f32 v[22:23], v[22:23], v[118:119]
  v_lshlrev_b32 v112, 16, v108
  v_and_b32 v113, 0xffff0000, v108
  v_lshlrev_b32 v114, 16, v109
  v_and_b32 v115, 0xffff0000, v109
  v_pk_add_f32 v[24:25], v[24:25], v[112:113]
  v_pk_add_f32 v[26:27], v[26:27], v[114:115]
  v_lshlrev_b32 v116, 16, v110
  v_and_b32 v117, 0xffff0000, v110
  v_lshlrev_b32 v118, 16, v111
  v_and_b32 v119, 0xffff0000, v111
  v_pk_add_f32 v[28:29], v[28:29], v[116:117]
  v_pk_add_f32 v[30:31], v[30:31], v[118:119]
  v_cvt_pk_bf16_f32 v64, v0, v1
  v_cvt_pk_bf16_f32 v65, v2, v3
  v_cvt_pk_bf16_f32 v66, v4, v5
  v_cvt_pk_bf16_f32 v67, v6, v7
  v_cvt_pk_bf16_f32 v68, v8, v9
  v_cvt_pk_bf16_f32 v69, v10, v11
  v_cvt_pk_bf16_f32 v70, v12, v13
  v_cvt_pk_bf16_f32 v71, v14, v15
  v_cvt_pk_bf16_f32 v72, v16, v17
  v_cvt_pk_bf16_f32 v73, v18, v19
  v_cvt_pk_bf16_f32 v74, v20, v21
  v_cvt_pk_bf16_f32 v75, v22, v23
  v_cvt_pk_bf16_f32 v76, v24, v25
  v_cvt_pk_bf16_f32 v77, v26, v27
  v_cvt_pk_bf16_f32 v78, v28, v29
  v_cvt_pk_bf16_f32 v79, v30, v31
  buffer_store_dwordx2 v[64:65], v230, s[32:35], s80 offen offset:0 sc1
  buffer_store_dwordx2 v[66:67], v230, s[32:35], s81 offen offset:0 sc1
  buffer_store_dwordx2 v[68:69], v230, s[32:35], s82 offen offset:0 sc1
  buffer_store_dwordx2 v[70:71], v230, s[32:35], s83 offen offset:0 sc1
  buffer_store_dwordx2 v[72:73], v230, s[32:35], s80 offen offset:512 sc1
  buffer_store_dwordx2 v[74:75], v230, s[32:35], s81 offen offset:512 sc1
  buffer_store_dwordx2 v[76:77], v230, s[32:35], s82 offen offset:512 sc1
  buffer_store_dwordx2 v[78:79], v230, s[32:35], s83 offen offset:512 sc1
  v_pk_add_f32 v[128:129], v[0:1], v[2:3]
  v_pk_mul_f32 v[130:131], v[0:1], v[0:1]
  v_pk_fma_f32 v[130:131], v[2:3], v[2:3], v[130:131]
  v_pk_add_f32 v[128:129], v[128:129], v[4:5]
  v_pk_fma_f32 v[130:131], v[4:5], v[4:5], v[130:131]
  v_pk_add_f32 v[128:129], v[128:129], v[6:7]
  v_pk_fma_f32 v[130:131], v[6:7], v[6:7], v[130:131]
  v_pk_add_f32 v[128:129], v[128:129], v[8:9]
  v_pk_fma_f32 v[130:131], v[8:9], v[8:9], v[130:131]
  v_pk_add_f32 v[128:129], v[128:129], v[10:11]
  v_pk_fma_f32 v[130:131], v[10:11], v[10:11], v[130:131]
  v_pk_add_f32 v[128:129], v[128:129], v[12:13]
  v_pk_fma_f32 v[130:131], v[12:13], v[12:13], v[130:131]
  v_pk_add_f32 v[128:129], v[128:129], v[14:15]
  v_pk_fma_f32 v[130:131], v[14:15], v[14:15], v[130:131]
  v_pk_add_f32 v[132:133], v[16:17], v[18:19]
  v_pk_mul_f32 v[134:135], v[16:17], v[16:17]
  v_pk_fma_f32 v[134:135], v[18:19], v[18:19], v[134:135]
  v_pk_add_f32 v[132:133], v[132:133], v[20:21]
  v_pk_fma_f32 v[134:135], v[20:21], v[20:21], v[134:135]
  v_pk_add_f32 v[132:133], v[132:133], v[22:23]
  v_pk_fma_f32 v[134:135], v[22:23], v[22:23], v[134:135]
  v_pk_add_f32 v[132:133], v[132:133], v[24:25]
  v_pk_fma_f32 v[134:135], v[24:25], v[24:25], v[134:135]
  v_pk_add_f32 v[132:133], v[132:133], v[26:27]
  v_pk_fma_f32 v[134:135], v[26:27], v[26:27], v[134:135]
  v_pk_add_f32 v[132:133], v[132:133], v[28:29]
  v_pk_fma_f32 v[134:135], v[28:29], v[28:29], v[134:135]
  v_pk_add_f32 v[132:133], v[132:133], v[30:31]
  v_pk_fma_f32 v[134:135], v[30:31], v[30:31], v[134:135]
  v_add_f32 v128, v128, v129
  v_add_f32 v129, v130, v131
  v_add_f32 v132, v132, v133
  v_add_f32 v133, v134, v135
  v_mov_b32 v130, v128
  v_mov_b32 v131, v129
  v_mov_b32 v134, v132
  v_mov_b32 v135, v133
  s_nop 1
  v_permlane16_swap_b32 v128, v130
  v_permlane16_swap_b32 v129, v131
  v_permlane16_swap_b32 v132, v134
  v_permlane16_swap_b32 v133, v135
  s_nop 1
  v_add_f32 v128, v128, v130
  v_add_f32 v129, v129, v131
  v_add_f32 v132, v132, v134
  v_add_f32 v133, v133, v135
  v_mov_b32 v130, v128
  v_mov_b32 v131, v129
  v_mov_b32 v134, v132
  v_mov_b32 v135, v133
  s_nop 1
  v_permlane32_swap_b32 v128, v130
  v_permlane32_swap_b32 v129, v131
  v_permlane32_swap_b32 v132, v134
  v_permlane32_swap_b32 v133, v135
  s_nop 1
  v_add_f32 v128, v128, v130
  v_add_f32 v129, v129, v131
  v_add_f32 v132, v132, v134
  v_add_f32 v133, v133, v135
  s_mov_b64 exec, 0xffff
  buffer_store_dwordx2 v[128:129], v231, s[40:43], 0 offen sc1
  buffer_store_dwordx2 v[132:133], v231, s[40:43], 0 offen offset:128 sc1
  s_mov_b64 exec, -1
  s_waitcnt vmcnt(0)
  s_barrier
  s_lshl_b32 s61, s90, 6
  v_and_b32 v240, 15, v255
  v_add_u32 v240, s61, v240
  v_lshlrev_b32 v240, 5, v240
  v_lshrrev_b32 v241, 5, v255
  v_lshl_add_u32 v240, v241, 12, v240
  v_bfe_u32 v241, v255, 4, 1
  v_lshl_add_u32 v236, v241, 4, v240
  v_lshrrev_b32 v240, 4, v255
  v_bfe_u32 v241, v255, 2, 2
  v_lshl_add_u32 v239, v240, 3, v241
  v_lshlrev_b32 v239, 7, v239
  v_and_b32 v242, 3, v255
  v_lshl_add_u32 v239, v242, 3, v239
  v_add_u32 v239, 16384, v239
  v_and_b32 v240, 1, v240
  v_lshlrev_b32 v240, 1, v240
  v_lshrrev_b32 v241, 1, v241
  v_or_b32 v238, v240, v241
  s_and_b32 s59, s73, 1
  s_lshl_b32 s59, s59, 1
  s_mul_i32 s60, s91, 7
  s_add_u32 s59, s59, s60
  s_add_u32 s80, s59, 0
  s_and_b32 s52, s80, 3
  s_lshr_b32 s60, s80, 2
  s_lshl_b32 s60, s60, 13
  v_xor_b32 v240, s52, v238
  v_lshl_add_u32 v240, v240, 5, v239
  v_add_u32 v224, s60, v240
  s_add_u32 s81, s59, 1
  s_and_b32 s52, s81, 3
  s_lshr_b32 s60, s81, 2
  s_lshl_b32 s60, s60, 13
  v_xor_b32 v240, s52, v238
  v_lshl_add_u32 v240, v240, 5, v239
  v_add_u32 v225, s60, v240
  s_add_u32 s82, s59, 2
  s_and_b32 s52, s82, 3
  s_lshr_b32 s60, s82, 2
  s_lshl_b32 s60, s60, 13
  v_xor_b32 v240, s52, v238
  v_lshl_add_u32 v240, v240, 5, v239
  v_add_u32 v226, s60, v240
  s_add_u32 s83, s59, 3
  s_and_b32 s52, s83, 3
  s_lshr_b32 s60, s83, 2
  s_lshl_b32 s60, s60, 13
  v_xor_b32 v240, s52, v238
  v_lshl_add_u32 v240, v240, 5, v239
  v_add_u32 v227, s60, v240
  s_add_u32 s84, s59, 4
  s_and_b32 s52, s84, 3
  s_lshr_b32 s60, s84, 2
  s_lshl_b32 s60, s60, 13
  v_xor_b32 v240, s52, v238
  v_lshl_add_u32 v240, v240, 5, v239
  v_add_u32 v228, s60, v240
  s_add_u32 s85, s59, 5
  s_and_b32 s52, s85, 3
  s_lshr_b32 s60, s85, 2
  s_lshl_b32 s60, s60, 13
  v_xor_b32 v240, s52, v238
  v_lshl_add_u32 v240, v240, 5, v239
  v_add_u32 v229, s60, v240
  s_add_u32 s86, s59, 6
  s_and_b32 s52, s86, 3
  s_lshr_b32 s60, s86, 2
  s_lshl_b32 s60, s60, 13
  v_xor_b32 v240, s52, v238
  v_lshl_add_u32 v240, v240, 5, v239
  v_add_u32 v230, s60, v240
  v_mov_b32 v0, 0
  v_mov_b32 v1, 0
  v_mov_b32 v2, 0
  v_mov_b32 v3, 0
  v_mov_b32 v4, 0
  v_mov_b32 v5, 0
  v_mov_b32 v6, 0
  v_mov_b32 v7, 0
  v_mov_b32 v8, 0
  v_mov_b32 v9, 0
  v_mov_b32 v10, 0
  v_mov_b32 v11, 0
  v_mov_b32 v12, 0
  v_mov_b32 v13, 0
  v_mov_b32 v14, 0
  v_mov_b32 v15, 0
  v_mov_b32 v16, 0
  v_mov_b32 v17, 0
  v_mov_b32 v18, 0
  v_mov_b32 v19, 0
  v_mov_b32 v20, 0
  v_mov_b32 v21, 0
  v_mov_b32 v22, 0
  v_mov_b32 v23, 0
  v_mov_b32 v24, 0
  v_mov_b32 v25, 0
  v_mov_b32 v26, 0
  v_mov_b32 v27, 0
  v_mov_b32 v28, 0
  v_mov_b32 v29, 0
  v_mov_b32 v30, 0
  v_mov_b32 v31, 0
  v_mov_b32 v32, 0
  v_mov_b32 v33, 0
  v_mov_b32 v34, 0
  v_mov_b32 v35, 0
  v_mov_b32 v36, 0
  v_mov_b32 v37, 0
  v_mov_b32 v38, 0
  v_mov_b32 v39, 0
  v_mov_b32 v40, 0
  v_mov_b32 v41, 0
  v_mov_b32 v42, 0
  v_mov_b32 v43, 0
  v_mov_b32 v44, 0
  v_mov_b32 v45, 0
  v_mov_b32 v46, 0
  v_mov_b32 v47, 0
  v_mov_b32 v48, 0
  v_mov_b32 v49, 0
  v_mov_b32 v50, 0
  v_mov_b32 v51, 0
  v_mov_b32 v52, 0
  v_mov_b32 v53, 0
  v_mov_b32 v54, 0
  v_mov_b32 v55, 0
  v_mov_b32 v56, 0
  v_mov_b32 v57, 0
  v_mov_b32 v58, 0
  v_mov_b32 v59, 0
  v_mov_b32 v60, 0
  v_mov_b32 v61, 0
  v_mov_b32 v62, 0
  v_mov_b32 v63, 0
  v_mov_b32 v64, 0
  v_mov_b32 v65, 0
  v_mov_b32 v66, 0
  v_mov_b32 v67, 0
  v_mov_b32 v68, 0
  v_mov_b32 v69, 0
  v_mov_b32 v70, 0
  v_mov_b32 v71, 0
  v_mov_b32 v72, 0
  v_mov_b32 v73, 0
  v_mov_b32 v74, 0
  v_mov_b32 v75, 0
  v_mov_b32 v76, 0
  v_mov_b32 v77, 0
  v_mov_b32 v78, 0
  v_mov_b32 v79, 0
  v_mov_b32 v80, 0
  v_mov_b32 v81, 0
  v_mov_b32 v82, 0
  v_mov_b32 v83, 0
  v_mov_b32 v84, 0
  v_mov_b32 v85, 0
  v_mov_b32 v86, 0
  v_mov_b32 v87, 0
  v_mov_b32 v88, 0
  v_mov_b32 v89, 0
  v_mov_b32 v90, 0
  v_mov_b32 v91, 0
  v_mov_b32 v92, 0
  v_mov_b32 v93, 0
  v_mov_b32 v94, 0
  v_mov_b32 v95, 0
  v_mov_b32 v96, 0
  v_mov_b32 v97, 0
  v_mov_b32 v98, 0
  v_mov_b32 v99, 0
  v_mov_b32 v100, 0
  v_mov_b32 v101, 0
  v_mov_b32 v102, 0
  v_mov_b32 v103, 0
  v_mov_b32 v104, 0
  v_mov_b32 v105, 0
  v_mov_b32 v106, 0
  v_mov_b32 v107, 0
  v_mov_b32 v108, 0
  v_mov_b32 v109, 0
  v_mov_b32 v110, 0
  v_mov_b32 v111, 0
  s_mul_i32 s60, s71, 524288
  s_add_u32 s60, s60, 33816576
  s_lshl_b32 s59, s72, 10
  s_add_u32 s60, s60, s59
  s_add_u32 s40, s20, s60
  s_addc_u32 s41, s21, 0
  s_mov_b32 s42, 262144
  s_mov_b32 s43, 0x00020000
  s_lshl_b32 s59, s73, 14
  s_add_u32 s44, s20, 34865152
  s_addc_u32 s45, s21, 0
  s_add_u32 s44, s44, s59
  s_addc_u32 s45, s45, 0
  s_mov_b32 s46, 16384
  s_mov_b32 s47, 0x00020000
  s_lshl_b32 s52, s48, 6
  v_add_u32 v243, s52, v255
  v_lshlrev_b32 v244, 2, v243
  buffer_load_dword v128, v244, s[44:47], 0 offen offset:0 sc1
  buffer_load_dword v129, v244, s[44:47], 0 offen offset:1024 sc1
  buffer_load_dword v130, v244, s[44:47], 0 offen offset:2048 sc1
  buffer_load_dword v131, v244, s[44:47], 0 offen offset:3072 sc1
  s_mov_b32 s59, 4096
  buffer_load_dword v132, v244, s[44:47], s59 offen offset:0 sc1
  buffer_load_dword v133, v244, s[44:47], s59 offen offset:1024 sc1
  buffer_load_dword v134, v244, s[44:47], s59 offen offset:2048 sc1
  buffer_load_dword v135, v244, s[44:47], s59 offen offset:3072 sc1
  s_mov_b32 s59, 8192
  buffer_load_dword v136, v244, s[44:47], s59 offen offset:0 sc1
  buffer_load_dword v137, v244, s[44:47], s59 offen offset:1024 sc1
  buffer_load_dword v138, v244, s[44:47], s59 offen offset:2048 sc1
  buffer_load_dword v139, v244, s[44:47], s59 offen offset:3072 sc1
  s_mov_b32 s59, 12288
  buffer_load_dword v140, v244, s[44:47], s59 offen offset:0 sc1
  buffer_load_dword v141, v244, s[44:47], s59 offen offset:1024 sc1
  buffer_load_dword v142, v244, s[44:47], s59 offen offset:2048 sc1
  buffer_load_dword v143, v244, s[44:47], s59 offen offset:3072 sc1
  v_and_b32 v245, 31, v255
  s_lshl_b32 s52, s48, 5
  v_add_u32 v245, s52, v245
  v_lshrrev_b32 v241, 5, v255
  v_lshlrev_b32 v242, 3, v245
  v_lshl_add_u32 v242, v241, 17, v242
  s_waitcnt vmcnt(0)
  v_pk_add_f32 v[128:129], v[128:129], v[136:137]
  v_pk_add_f32 v[130:131], v[130:131], v[138:139]
  v_pk_add_f32 v[132:133], v[132:133], v[140:141]
  v_pk_add_f32 v[134:135], v[134:135], v[142:143]
  v_pk_add_f32 v[128:129], v[128:129], v[132:133]
  v_pk_add_f32 v[130:131], v[130:131], v[134:135]
  v_pk_add_f32 v[128:129], v[128:129], v[130:131]
  v_add_f32 v128, v128, v129
  v_add_u32 v244, 148480, v244
  ds_write_b32 v244, v128
  s_lshl_b32 s63, s71, 2
  s_add_u32 s63, s63, 2
  v_mov_b32 v246, 152576
  s_mov_b32 s94, 0x1000000
L_fw_31:
  ds_read_b32 v247, v246
  s_waitcnt lgkmcnt(0)
  v_readfirstlane_b32 s52, v247
  s_nop 3
  s_cmp_ge_u32 s52, s63
  s_cbranch_scc1 L_fok_32
  s_sub_u32 s94, s94, 1
  s_cmp_eq_u32 s94, 0
  s_cbranch_scc1 L_fok_32
  s_sleep 1
  s_branch L_fw_31
L_fok_32:
  s_mov_b32 s52, 0
  buffer_load_dwordx2 v[200:201], v242, s[40:43], s52 offen sc1
  s_mov_b32 s52, 16384
  buffer_load_dwordx2 v[202:203], v242, s[40:43], s52 offen sc1
  s_mov_b32 s52, 32768
  buffer_load_dwordx2 v[204:205], v242, s[40:43], s52 offen sc1
  s_mov_b32 s52, 49152
  buffer_load_dwordx2 v[206:207], v242, s[40:43], s52 offen sc1
  s_mov_b32 s52, 65536
  buffer_load_dwordx2 v[208:209], v242, s[40:43], s52 offen sc1
  s_mov_b32 s52, 81920
  buffer_load_dwordx2 v[210:211], v242, s[40:43], s52 offen sc1
  s_mov_b32 s52, 98304
  buffer_load_dwordx2 v[212:213], v242, s[40:43], s52 offen sc1
  s_mov_b32 s52, 114688
  buffer_load_dwordx2 v[214:215], v242, s[40:43], s52 offen sc1
  s_mov_b32 s95, 14
  s_mov_b32 s53, 16
  s_mov_b32 s51, 49152
  s_mov_b32 s62, 49152
  s_barrier
  ds_read_b128 v[112:115], v236 offset:0
  ds_read_b128 v[116:119], v236 offset:512
  ds_read_b128 v[120:123], v236 offset:1024
  ds_read_b128 v[124:127], v236 offset:1536
  ds_read_b64_tr_b16 v[144:145], v224 offset:0
  ds_read_b64_tr_b16 v[146:147], v224 offset:512
  ds_read_b64_tr_b16 v[148:149], v225 offset:0
  ds_read_b64_tr_b16 v[150:151], v225 offset:512
  ds_read_b64_tr_b16 v[152:153], v226 offset:0
  ds_read_b64_tr_b16 v[154:155], v226 offset:512
  ds_read_b64_tr_b16 v[156:157], v227 offset:0
  ds_read_b64_tr_b16 v[158:159], v227 offset:512
  ds_read_b64_tr_b16 v[160:161], v228 offset:0
  ds_read_b64_tr_b16 v[162:163], v228 offset:512
  ds_read_b64_tr_b16 v[164:165], v229 offset:0
  ds_read_b64_tr_b16 v[166:167], v229 offset:512
  ds_read_b64_tr_b16 v[168:169], v230 offset:0
  ds_read_b64_tr_b16 v[170:171], v230 offset:512
  .p2align 3
L_cl_33:
  s_waitcnt lgkmcnt(0)
  v_mfma_f32_16x16x32_bf16 v[0:3], v[144:147], v[112:115], v[0:3]
  ds_read_b128 v[128:131], v236 offset:8192
  v_mfma_f32_16x16x32_bf16 v[28:31], v[144:147], v[116:119], v[28:31]
  ds_read_b128 v[132:135], v236 offset:8704
  v_mfma_f32_16x16x32_bf16 v[56:59], v[144:147], v[120:123], v[56:59]
  ds_read_b128 v[136:139], v236 offset:9216
  v_mfma_f32_16x16x32_bf16 v[84:87], v[144:147], v[124:127], v[84:87]
  ds_read_b128 v[140:143], v236 offset:9728
  v_mfma_f32_16x16x32_bf16 v[4:7], v[148:151], v[112:115], v[4:7]
  ds_read_b64_tr_b16 v[172:173], v224 offset:4096
  v_mfma_f32_16x16x32_bf16 v[32:35], v[148:151], v[116:119], v[32:35]
  ds_read_b64_tr_b16 v[174:175], v224 offset:4608
  v_mfma_f32_16x16x32_bf16 v[60:63], v[148:151], v[120:123], v[60:63]
  ds_read_b64_tr_b16 v[176:177], v225 offset:4096
  v_mfma_f32_16x16x32_bf16 v[88:91], v[148:151], v[124:127], v[88:91]
  ds_read_b64_tr_b16 v[178:179], v225 offset:4608
  v_mfma_f32_16x16x32_bf16 v[8:11], v[152:155], v[112:115], v[8:11]
  ds_read_b64_tr_b16 v[180:181], v226 offset:4096
  v_mfma_f32_16x16x32_bf16 v[36:39], v[152:155], v[116:119], v[36:39]
  ds_read_b64_tr_b16 v[182:183], v226 offset:4608
  v_mfma_f32_16x16x32_bf16 v[64:67], v[152:155], v[120:123], v[64:67]
  ds_read_b64_tr_b16 v[184:185], v227 offset:4096
  v_mfma_f32_16x16x32_bf16 v[92:95], v[152:155], v[124:127], v[92:95]
  ds_read_b64_tr_b16 v[186:187], v227 offset:4608
  v_mfma_f32_16x16x32_bf16 v[12:15], v[156:159], v[112:115], v[12:15]
  ds_read_b64_tr_b16 v[188:189], v228 offset:4096
  v_mfma_f32_16x16x32_bf16 v[40:43], v[156:159], v[116:119], v[40:43]
  ds_read_b64_tr_b16 v[190:191], v228 offset:4608
  v_mfma_f32_16x16x32_bf16 v[68:71], v[156:159], v[120:123], v[68:71]
  ds_read_b64_tr_b16 v[192:193], v229 offset:4096
  v_mfma_f32_16x16x32_bf16 v[96:99], v[156:159], v[124:127], v[96:99]
  ds_read_b64_tr_b16 v[194:195], v229 offset:4608
  v_mfma_f32_16x16x32_bf16 v[16:19], v[160:163], v[112:115], v[16:19]
  ds_read_b64_tr_b16 v[196:197], v230 offset:4096
  v_mfma_f32_16x16x32_bf16 v[44:47], v[160:163], v[116:119], v[44:47]
  ds_read_b64_tr_b16 v[198:199], v230 offset:4608
  v_mfma_f32_16x16x32_bf16 v[72:75], v[160:163], v[120:123], v[72:75]
  v_add_u32 v236, s62, v236
  v_mfma_f32_16x16x32_bf16 v[100:103], v[160:163], v[124:127], v[100:103]
  v_add_u32 v224, s62, v224
  v_mfma_f32_16x16x32_bf16 v[20:23], v[164:167], v[112:115], v[20:23]
  v_add_u32 v225, s62, v225
  v_mfma_f32_16x16x32_bf16 v[48:51], v[164:167], v[116:119], v[48:51]
  v_add_u32 v226, s62, v226
  v_mfma_f32_16x16x32_bf16 v[76:79], v[164:167], v[120:123], v[76:79]
  v_add_u32 v227, s62, v227
  v_mfma_f32_16x16x32_bf16 v[104:107], v[164:167], v[124:127], v[104:107]
  v_add_u32 v228, s62, v228
  v_mfma_f32_16x16x32_bf16 v[24:27], v[168:171], v[112:115], v[24:27]
  v_add_u32 v229, s62, v229
  v_mfma_f32_16x16x32_bf16 v[52:55], v[168:171], v[116:119], v[52:55]
  v_add_u32 v230, s62, v230
  v_mfma_f32_16x16x32_bf16 v[80:83], v[168:171], v[120:123], v[80:83]
  s_cmp_eq_u32 s95, s53
  v_mfma_f32_16x16x32_bf16 v[108:111], v[168:171], v[124:127], v[108:111]
  s_cbranch_scc1 L_hk_34
L_hb_35:
  s_waitcnt lgkmcnt(0)
  v_mfma_f32_16x16x32_bf16 v[0:3], v[172:175], v[128:131], v[0:3]
  s_barrier
  v_mfma_f32_16x16x32_bf16 v[28:31], v[172:175], v[132:135], v[28:31]
  ds_read_b128 v[112:115], v236 offset:0
  v_mfma_f32_16x16x32_bf16 v[56:59], v[172:175], v[136:139], v[56:59]
  ds_read_b128 v[116:119], v236 offset:512
  v_mfma_f32_16x16x32_bf16 v[84:87], v[172:175], v[140:143], v[84:87]
  ds_read_b128 v[120:123], v236 offset:1024
  v_mfma_f32_16x16x32_bf16 v[4:7], v[176:179], v[128:131], v[4:7]
  ds_read_b128 v[124:127], v236 offset:1536
  v_mfma_f32_16x16x32_bf16 v[32:35], v[176:179], v[132:135], v[32:35]
  ds_read_b64_tr_b16 v[144:145], v224 offset:0
  v_mfma_f32_16x16x32_bf16 v[60:63], v[176:179], v[136:139], v[60:63]
  ds_read_b64_tr_b16 v[146:147], v224 offset:512
  v_mfma_f32_16x16x32_bf16 v[88:91], v[176:179], v[140:143], v[88:91]
  ds_read_b64_tr_b16 v[148:149], v225 offset:0
  v_mfma_f32_16x16x32_bf16 v[8:11], v[180:183], v[128:131], v[8:11]
  ds_read_b64_tr_b16 v[150:151], v225 offset:512
  v_mfma_f32_16x16x32_bf16 v[36:39], v[180:183], v[132:135], v[36:39]
  ds_read_b64_tr_b16 v[152:153], v226 offset:0
  v_mfma_f32_16x16x32_bf16 v[64:67], v[180:183], v[136:139], v[64:67]
  ds_read_b64_tr_b16 v[154:155], v226 offset:512
  v_mfma_f32_16x16x32_bf16 v[92:95], v[180:183], v[140:143], v[92:95]
  ds_read_b64_tr_b16 v[156:157], v227 offset:0
  v_mfma_f32_16x16x32_bf16 v[12:15], v[184:187], v[128:131], v[12:15]
  ds_read_b64_tr_b16 v[158:159], v227 offset:512
  v_mfma_f32_16x16x32_bf16 v[40:43], v[184:187], v[132:135], v[40:43]
  ds_read_b64_tr_b16 v[160:161], v228 offset:0
  v_mfma_f32_16x16x32_bf16 v[68:71], v[184:187], v[136:139], v[68:71]
  ds_read_b64_tr_b16 v[162:163], v228 offset:512
  v_mfma_f32_16x16x32_bf16 v[96:99], v[184:187], v[140:143], v[96:99]
  ds_read_b64_tr_b16 v[164:165], v229 offset:0
  v_mfma_f32_16x16x32_bf16 v[16:19], v[188:191], v[128:131], v[16:19]
  ds_read_b64_tr_b16 v[166:167], v229 offset:512
  v_mfma_f32_16x16x32_bf16 v[44:47], v[188:191], v[132:135], v[44:47]
  ds_read_b64_tr_b16 v[168:169], v230 offset:0
  v_mfma_f32_16x16x32_bf16 v[72:75], v[188:191], v[136:139], v[72:75]
  ds_read_b64_tr_b16 v[170:171], v230 offset:512
  v_mfma_f32_16x16x32_bf16 v[100:103], v[188:191], v[140:143], v[100:103]
  s_add_u32 s52, s51, 49152
  v_mfma_f32_16x16x32_bf16 v[20:23], v[192:195], v[128:131], v[20:23]
  s_cmp_eq_u32 s52, 147456
  v_mfma_f32_16x16x32_bf16 v[48:51], v[192:195], v[132:135], v[48:51]
  s_cselect_b32 s52, 0, s52
  v_mfma_f32_16x16x32_bf16 v[76:79], v[192:195], v[136:139], v[76:79]
  s_sub_u32 s62, s52, s51
  v_mfma_f32_16x16x32_bf16 v[104:107], v[192:195], v[140:143], v[104:107]
  s_mov_b32 s51, s52
  v_mfma_f32_16x16x32_bf16 v[24:27], v[196:199], v[128:131], v[24:27]
  s_sub_u32 s53, s53, 1
  v_mfma_f32_16x16x32_bf16 v[52:55], v[196:199], v[132:135], v[52:55]
  s_cmp_lg_u32 s53, 0
  v_mfma_f32_16x16x32_bf16 v[80:83], v[196:199], v[136:139], v[80:83]
  v_mfma_f32_16x16x32_bf16 v[108:111], v[196:199], v[140:143], v[108:111]
  s_cbranch_scc1 L_cl_33
  s_branch L_ov_36
L_hk_34:
  s_cmp_lg_u32 s95, 14
  s_cbranch_scc1 L_hn_37
  s_waitcnt vmcnt(0)
  v_pk_add_f32 v[200:201], v[200:201], v[208:209]
  v_pk_add_f32 v[202:203], v[202:203], v[210:211]
  v_pk_add_f32 v[204:205], v[204:205], v[212:213]
  v_pk_add_f32 v[206:207], v[206:207], v[214:215]
  v_pk_add_f32 v[200:201], v[200:201], v[204:205]
  v_pk_add_f32 v[202:203], v[202:203], v[206:207]
  v_pk_add_f32 v[200:201], v[200:201], v[202:203]
  v_and_b32 v245, 31, v255
  s_lshl_b32 s52, s48, 5
  v_add_u32 v245, s52, v245
  v_mov_b32 v202, v200
  v_mov_b32 v203, v201
  v_lshlrev_b32 v245, 2, v245
  v_add_u32 v245, 147456, v245
  v_permlane32_swap_b32 v200, v202
  v_permlane32_swap_b32 v201, v203
  s_nop 1
  v_add_f32 v200, v200, v202
  v_add_f32 v201, v201, v203
  v_mul_f32 v200, 0x3a800000, v200
  v_mul_f32 v201, 0x3a800000, v201
  v_fma_f32 v201, -v200, v200, v201
  v_max_f32 v201, 0, v201
  v_add_f32 v201, 0x3727c5ac, v201
  v_rsq_f32 v201, v201
  v_sub_f32 v200, 0, v200
  ds_write_b32 v245, v200
  ds_write_b32 v245, v201 offset:512
  s_mov_b32 s95, 13
  s_branch L_hb_35
L_hn_37:
  s_cmp_lg_u32 s95, 13
  s_cbranch_scc1 L_hn_38
  s_cmp_lg_u32 s71, 0
  s_cbranch_scc1 L_l0o_39
  s_lshl_b32 s59, s75, 7
  s_sub_u32 s60, 7340032, s59
  s_add_u32 s44, s14, s59
  s_addc_u32 s45, s15, 0
  s_mov_b32 s46, s60
  s_mov_b32 s47, 0x00020000
  s_mul_i32 s59, s74, 28
  s_mul_i32 s60, s48, 7
  s_add_u32 s59, s59, s60
  v_lshrrev_b32 v240, 3, v255
  v_and_b32 v241, 7, v255
  v_bfe_u32 v242, v255, 4, 1
  v_lshlrev_b32 v240, 11, v240
  v_lshlrev_b32 v243, 1, v242
  v_xor_b32 v243, v243, v241
  v_lshl_add_u32 v243, v243, 4, v240
  v_or_b32 v242, 2, v242
  v_lshlrev_b32 v242, 1, v242
  v_xor_b32 v242, v242, v241
  v_lshl_add_u32 v242, v242, 4, v240
  s_and_b32 s60, s59, 1
  s_cmp_eq_u32 s60, 0
  s_cselect_b64 vcc, -1, 0
  s_nop 1
  v_cndmask_b32 v244, v242, v243, vcc
  v_cndmask_b32 v245, v243, v242, vcc
  s_lshl_b32 s60, s59, 14
  buffer_load_dwordx4 v[200:203], v244, s[44:47], s60 offen
  s_add_u32 s60, s60, 16384
  buffer_load_dwordx4 v[204:207], v245, s[44:47], s60 offen
  s_add_u32 s60, s60, 16384
  buffer_load_dwordx4 v[208:211], v244, s[44:47], s60 offen
  s_add_u32 s60, s60, 16384
  buffer_load_dwordx4 v[212:215], v245, s[44:47], s60 offen
  s_add_u32 s60, s60, 16384
  buffer_load_dwordx4 v[216:219], v244, s[44:47], s60 offen
  s_add_u32 s60, s60, 16384
  buffer_load_dwordx4 v[220:223], v245, s[44:47], s60 offen
  s_add_u32 s60, s60, 16384
  buffer_load_dwordx4 v[232:235], v244, s[44:47], s60 offen
L_l0o_39:
  s_mov_b32 s95, 6
  s_branch L_hb_35
L_hn_38:
  s_cmp_lg_u32 s95, 6
  s_cbranch_scc1 L_hn_40
  s_cmp_lg_u32 s71, 0
  s_cbranch_scc1 L_l0o_41
  s_waitcnt vmcnt(0)
  s_mul_i32 s59, s75, 458752
  s_mul_i32 s60, s74, 28672
  s_add_u32 s59, s59, s60
  s_mul_i32 s60, s48, 7168
  s_add_u32 s59, s59, s60
  s_add_u32 s44, s20, 41943040
  s_addc_u32 s45, s21, 0
  s_add_u32 s44, s44, s59
  s_addc_u32 s45, s45, 0
  s_mov_b32 s46, 7168
  s_mov_b32 s47, 0x00020000
  v_lshlrev_b32 v240, 4, v255
  buffer_store_dwordx4 v[200:203], v240, s[44:47], 0 offen offset:0 sc1
  buffer_store_dwordx4 v[204:207], v240, s[44:47], 0 offen offset:1024 sc1
  buffer_store_dwordx4 v[208:211], v240, s[44:47], 0 offen offset:2048 sc1
  buffer_store_dwordx4 v[212:215], v240, s[44:47], 0 offen offset:3072 sc1
  s_mov_b32 s59, 4096
  buffer_store_dwordx4 v[216:219], v240, s[44:47], s59 offen offset:0 sc1
  buffer_store_dwordx4 v[220:223], v240, s[44:47], s59 offen offset:1024 sc1
  buffer_store_dwordx4 v[232:235], v240, s[44:47], s59 offen offset:2048 sc1
L_l0o_41:
  s_mov_b32 s95, 1
  s_branch L_hb_35
L_hn_40:
  s_cmp_lg_u32 s71, 0
  s_cbranch_scc1 L_l0o_43
  s_waitcnt vmcnt(0)
  s_add_u32 s60, s75, 192
  s_lshl_b32 s60, s60, 7
  v_mov_b32 v240, 0
  v_mov_b32 v241, 1
  s_mov_b64 exec, 1
  buffer_atomic_add v241, v240, s[76:79], s60 offen sc1
  s_mov_b64 exec, -1
L_l0o_43:
  s_mov_b32 s95, -1
  s_branch L_hb_35
L_hn_42:
L_ov_36:
  s_waitcnt lgkmcnt(0)
  s_nop 7
  s_nop 1
  v_lshrrev_b32 v240, 4, v255
  v_lshlrev_b32 v243, 4, v240
  v_add_u32 v243, 148480, v243
  s_lshl_b32 s52, s80, 6
  v_add_u32 v241, s52, v243
  ds_read_b128 v[112:115], v241
  s_lshl_b32 s52, s81, 6
  v_add_u32 v241, s52, v243
  ds_read_b128 v[116:119], v241
  s_lshl_b32 s52, s82, 6
  v_add_u32 v241, s52, v243
  ds_read_b128 v[120:123], v241
  s_lshl_b32 s52, s83, 6
  v_add_u32 v241, s52, v243
  ds_read_b128 v[124:127], v241
  s_lshl_b32 s52, s84, 6
  v_add_u32 v241, s52, v243
  ds_read_b128 v[128:131], v241
  s_lshl_b32 s52, s85, 6
  v_add_u32 v241, s52, v243
  ds_read_b128 v[132:135], v241
  s_lshl_b32 s52, s86, 6
  v_add_u32 v241, s52, v243
  ds_read_b128 v[136:139], v241
  v_and_b32 v242, 15, v255
  v_add_u32 v242, s61, v242
  v_lshlrev_b32 v241, 2, v242
  v_add_u32 v241, 147456, v241
  ds_read_b32 v140, v241 offset:0
  ds_read_b32 v141, v241 offset:512
  ds_read_b32 v144, v241 offset:64
  ds_read_b32 v145, v241 offset:576
  ds_read_b32 v148, v241 offset:128
  ds_read_b32 v149, v241 offset:640
  ds_read_b32 v152, v241 offset:192
  ds_read_b32 v153, v241 offset:704
  v_lshlrev_b32 v230, 5, v242
  v_lshl_add_u32 v230, v240, 3, v230
  s_mul_i32 s59, s73, 14
  s_mul_i32 s60, s91, 7
  s_add_u32 s59, s59, s60
  s_add_u32 s80, s59, 0
  s_lshl_b32 s80, s80, 12
  s_add_u32 s81, s59, 1
  s_lshl_b32 s81, s81, 12
  s_add_u32 s82, s59, 2
  s_lshl_b32 s82, s82, 12
  s_add_u32 s83, s59, 3
  s_lshl_b32 s83, s83, 12
  s_add_u32 s84, s59, 4
  s_lshl_b32 s84, s84, 12
  s_add_u32 s85, s59, 5
  s_lshl_b32 s85, s85, 12
  s_add_u32 s86, s59, 6
  s_lshl_b32 s86, s86, 12
  s_mul_i32 s59, s72, 917504
  s_add_u32 s32, s20, 12582912
  s_addc_u32 s33, s21, 0
  s_add_u32 s32, s32, s59
  s_addc_u32 s33, s33, 0
  s_mov_b32 s34, 917504
  s_mov_b32 s35, 0x00020000
  s_waitcnt lgkmcnt(0)
  v_mul_f32 v142, 0xbfb8aa3b, v141
  v_mul_f32 v146, 0xbfb8aa3b, v145
  v_mul_f32 v150, 0xbfb8aa3b, v149
  v_mul_f32 v154, 0xbfb8aa3b, v153
  v_pk_fma_f32 v[160:161], v[112:113], v[140:141], v[0:1] op_sel_hi:[1,0,1]
  v_pk_fma_f32 v[164:165], v[114:115], v[140:141], v[2:3] op_sel_hi:[1,0,1]
  v_pk_fma_f32 v[168:169], v[112:113], v[144:145], v[28:29] op_sel_hi:[1,0,1]
  v_pk_fma_f32 v[172:173], v[114:115], v[144:145], v[30:31] op_sel_hi:[1,0,1]
  v_pk_mul_f32 v[162:163], v[160:161], v[142:143] op_sel_hi:[1,0]
  v_pk_mul_f32 v[166:167], v[164:165], v[142:143] op_sel_hi:[1,0]
  v_pk_mul_f32 v[170:171], v[168:169], v[146:147] op_sel_hi:[1,0]
  v_pk_mul_f32 v[174:175], v[172:173], v[146:147] op_sel_hi:[1,0]
  v_exp_f32 v162, v162
  v_exp_f32 v166, v166
  v_exp_f32 v170, v170
  v_exp_f32 v174, v174
  v_exp_f32 v163, v163
  v_exp_f32 v167, v167
  v_exp_f32 v171, v171
  v_exp_f32 v175, v175
  v_pk_mul_f32 v[160:161], v[160:161], v[140:141] op_sel:[0,1] op_sel_hi:[1,1]
  v_pk_mul_f32 v[164:165], v[164:165], v[140:141] op_sel:[0,1] op_sel_hi:[1,1]
  v_pk_mul_f32 v[168:169], v[168:169], v[144:145] op_sel:[0,1] op_sel_hi:[1,1]
  v_pk_mul_f32 v[172:173], v[172:173], v[144:145] op_sel:[0,1] op_sel_hi:[1,1]
  v_pk_add_f32 v[162:163], v[162:163], 1.0 op_sel_hi:[1,0]
  v_pk_add_f32 v[166:167], v[166:167], 1.0 op_sel_hi:[1,0]
  v_pk_add_f32 v[170:171], v[170:171], 1.0 op_sel_hi:[1,0]
  v_pk_add_f32 v[174:175], v[174:175], 1.0 op_sel_hi:[1,0]
  v_rcp_f32 v162, v162
  v_rcp_f32 v166, v166
  v_rcp_f32 v170, v170
  v_rcp_f32 v174, v174
  v_rcp_f32 v163, v163
  v_rcp_f32 v167, v167
  v_rcp_f32 v171, v171
  v_rcp_f32 v175, v175
  v_pk_mul_f32 v[160:161], v[160:161], v[162:163]
  v_pk_mul_f32 v[164:165], v[164:165], v[166:167]
  v_pk_mul_f32 v[168:169], v[168:169], v[170:171]
  v_pk_mul_f32 v[172:173], v[172:173], v[174:175]
  v_cvt_pk_bf16_f32 v192, v160, v161
  v_cvt_pk_bf16_f32 v193, v164, v165
  v_cvt_pk_bf16_f32 v194, v168, v169
  v_cvt_pk_bf16_f32 v195, v172, v173
  buffer_store_dwordx2 v[192:193], v230, s[32:35], s80 offen offset:0 sc1
  buffer_store_dwordx2 v[194:195], v230, s[32:35], s80 offen offset:512 sc1
  v_pk_fma_f32 v[176:177], v[112:113], v[148:149], v[56:57] op_sel_hi:[1,0,1]
  v_pk_fma_f32 v[180:181], v[114:115], v[148:149], v[58:59] op_sel_hi:[1,0,1]
  v_pk_fma_f32 v[184:185], v[112:113], v[152:153], v[84:85] op_sel_hi:[1,0,1]
  v_pk_fma_f32 v[188:189], v[114:115], v[152:153], v[86:87] op_sel_hi:[1,0,1]
  v_pk_mul_f32 v[178:179], v[176:177], v[150:151] op_sel_hi:[1,0]
  v_pk_mul_f32 v[182:183], v[180:181], v[150:151] op_sel_hi:[1,0]
  v_pk_mul_f32 v[186:187], v[184:185], v[154:155] op_sel_hi:[1,0]
  v_pk_mul_f32 v[190:191], v[188:189], v[154:155] op_sel_hi:[1,0]
  v_exp_f32 v178, v178
  v_exp_f32 v182, v182
  v_exp_f32 v186, v186
  v_exp_f32 v190, v190
  v_exp_f32 v179, v179
  v_exp_f32 v183, v183
  v_exp_f32 v187, v187
  v_exp_f32 v191, v191
  v_pk_mul_f32 v[176:177], v[176:177], v[148:149] op_sel:[0,1] op_sel_hi:[1,1]
  v_pk_mul_f32 v[180:181], v[180:181], v[148:149] op_sel:[0,1] op_sel_hi:[1,1]
  v_pk_mul_f32 v[184:185], v[184:185], v[152:153] op_sel:[0,1] op_sel_hi:[1,1]
  v_pk_mul_f32 v[188:189], v[188:189], v[152:153] op_sel:[0,1] op_sel_hi:[1,1]
  v_pk_add_f32 v[178:179], v[178:179], 1.0 op_sel_hi:[1,0]
  v_pk_add_f32 v[182:183], v[182:183], 1.0 op_sel_hi:[1,0]
  v_pk_add_f32 v[186:187], v[186:187], 1.0 op_sel_hi:[1,0]
  v_pk_add_f32 v[190:191], v[190:191], 1.0 op_sel_hi:[1,0]
  v_rcp_f32 v178, v178
  v_rcp_f32 v182, v182
  v_rcp_f32 v186, v186
  v_rcp_f32 v190, v190
  v_rcp_f32 v179, v179
  v_rcp_f32 v183, v183
  v_rcp_f32 v187, v187
  v_rcp_f32 v191, v191
  v_pk_mul_f32 v[176:177], v[176:177], v[178:179]
  v_pk_mul_f32 v[180:181], v[180:181], v[182:183]
  v_pk_mul_f32 v[184:185], v[184:185], v[186:187]
  v_pk_mul_f32 v[188:189], v[188:189], v[190:191]
  v_cvt_pk_bf16_f32 v196, v176, v177
  v_cvt_pk_bf16_f32 v197, v180, v181
  v_cvt_pk_bf16_f32 v198, v184, v185
  v_cvt_pk_bf16_f32 v199, v188, v189
  buffer_store_dwordx2 v[196:197], v230, s[32:35], s80 offen offset:1024 sc1
  buffer_store_dwordx2 v[198:199], v230, s[32:35], s80 offen offset:1536 sc1
  v_pk_fma_f32 v[160:161], v[116:117], v[140:141], v[4:5] op_sel_hi:[1,0,1]
  v_pk_fma_f32 v[164:165], v[118:119], v[140:141], v[6:7] op_sel_hi:[1,0,1]
  v_pk_fma_f32 v[168:169], v[116:117], v[144:145], v[32:33] op_sel_hi:[1,0,1]
  v_pk_fma_f32 v[172:173], v[118:119], v[144:145], v[34:35] op_sel_hi:[1,0,1]
  v_pk_mul_f32 v[162:163], v[160:161], v[142:143] op_sel_hi:[1,0]
  v_pk_mul_f32 v[166:167], v[164:165], v[142:143] op_sel_hi:[1,0]
  v_pk_mul_f32 v[170:171], v[168:169], v[146:147] op_sel_hi:[1,0]
  v_pk_mul_f32 v[174:175], v[172:173], v[146:147] op_sel_hi:[1,0]
  v_exp_f32 v162, v162
  v_exp_f32 v166, v166
  v_exp_f32 v170, v170
  v_exp_f32 v174, v174
  v_exp_f32 v163, v163
  v_exp_f32 v167, v167
  v_exp_f32 v171, v171
  v_exp_f32 v175, v175
  v_pk_mul_f32 v[160:161], v[160:161], v[140:141] op_sel:[0,1] op_sel_hi:[1,1]
  v_pk_mul_f32 v[164:165], v[164:165], v[140:141] op_sel:[0,1] op_sel_hi:[1,1]
  v_pk_mul_f32 v[168:169], v[168:169], v[144:145] op_sel:[0,1] op_sel_hi:[1,1]
  v_pk_mul_f32 v[172:173], v[172:173], v[144:145] op_sel:[0,1] op_sel_hi:[1,1]
  v_pk_add_f32 v[162:163], v[162:163], 1.0 op_sel_hi:[1,0]
  v_pk_add_f32 v[166:167], v[166:167], 1.0 op_sel_hi:[1,0]
  v_pk_add_f32 v[170:171], v[170:171], 1.0 op_sel_hi:[1,0]
  v_pk_add_f32 v[174:175], v[174:175], 1.0 op_sel_hi:[1,0]
  v_rcp_f32 v162, v162
  v_rcp_f32 v166, v166
  v_rcp_f32 v170, v170
  v_rcp_f32 v174, v174
  v_rcp_f32 v163, v163
  v_rcp_f32 v167, v167
  v_rcp_f32 v171, v171
  v_rcp_f32 v175, v175
  v_pk_mul_f32 v[160:161], v[160:161], v[162:163]
  v_pk_mul_f32 v[164:165], v[164:165], v[166:167]
  v_pk_mul_f32 v[168:169], v[168:169], v[170:171]
  v_pk_mul_f32 v[172:173], v[172:173], v[174:175]
  v_cvt_pk_bf16_f32 v192, v160, v161
  v_cvt_pk_bf16_f32 v193, v164, v165
  v_cvt_pk_bf16_f32 v194, v168, v169
  v_cvt_pk_bf16_f32 v195, v172, v173
  buffer_store_dwordx2 v[192:193], v230, s[32:35], s81 offen offset:0 sc1
  buffer_store_dwordx2 v[194:195], v230, s[32:35], s81 offen offset:512 sc1
  v_pk_fma_f32 v[176:177], v[116:117], v[148:149], v[60:61] op_sel_hi:[1,0,1]
  v_pk_fma_f32 v[180:181], v[118:119], v[148:149], v[62:63] op_sel_hi:[1,0,1]
  v_pk_fma_f32 v[184:185], v[116:117], v[152:153], v[88:89] op_sel_hi:[1,0,1]
  v_pk_fma_f32 v[188:189], v[118:119], v[152:153], v[90:91] op_sel_hi:[1,0,1]
  v_pk_mul_f32 v[178:179], v[176:177], v[150:151] op_sel_hi:[1,0]
  v_pk_mul_f32 v[182:183], v[180:181], v[150:151] op_sel_hi:[1,0]
  v_pk_mul_f32 v[186:187], v[184:185], v[154:155] op_sel_hi:[1,0]
  v_pk_mul_f32 v[190:191], v[188:189], v[154:155] op_sel_hi:[1,0]
  v_exp_f32 v178, v178
  v_exp_f32 v182, v182
  v_exp_f32 v186, v186
  v_exp_f32 v190, v190
  v_exp_f32 v179, v179
  v_exp_f32 v183, v183
  v_exp_f32 v187, v187
  v_exp_f32 v191, v191
  v_pk_mul_f32 v[176:177], v[176:177], v[148:149] op_sel:[0,1] op_sel_hi:[1,1]
  v_pk_mul_f32 v[180:181], v[180:181], v[148:149] op_sel:[0,1] op_sel_hi:[1,1]
  v_pk_mul_f32 v[184:185], v[184:185], v[152:153] op_sel:[0,1] op_sel_hi:[1,1]
  v_pk_mul_f32 v[188:189], v[188:189], v[152:153] op_sel:[0,1] op_sel_hi:[1,1]
  v_pk_add_f32 v[178:179], v[178:179], 1.0 op_sel_hi:[1,0]
  v_pk_add_f32 v[182:183], v[182:183], 1.0 op_sel_hi:[1,0]
  v_pk_add_f32 v[186:187], v[186:187], 1.0 op_sel_hi:[1,0]
  v_pk_add_f32 v[190:191], v[190:191], 1.0 op_sel_hi:[1,0]
  v_rcp_f32 v178, v178
  v_rcp_f32 v182, v182
  v_rcp_f32 v186, v186
  v_rcp_f32 v190, v190
  v_rcp_f32 v179, v179
  v_rcp_f32 v183, v183
  v_rcp_f32 v187, v187
  v_rcp_f32 v191, v191
  v_pk_mul_f32 v[176:177], v[176:177], v[178:179]
  v_pk_mul_f32 v[180:181], v[180:181], v[182:183]
  v_pk_mul_f32 v[184:185], v[184:185], v[186:187]
  v_pk_mul_f32 v[188:189], v[188:189], v[190:191]
  v_cvt_pk_bf16_f32 v196, v176, v177
  v_cvt_pk_bf16_f32 v197, v180, v181
  v_cvt_pk_bf16_f32 v198, v184, v185
  v_cvt_pk_bf16_f32 v199, v188, v189
  buffer_store_dwordx2 v[196:197], v230, s[32:35], s81 offen offset:1024 sc1
  buffer_store_dwordx2 v[198:199], v230, s[32:35], s81 offen offset:1536 sc1
  v_pk_fma_f32 v[160:161], v[120:121], v[140:141], v[8:9] op_sel_hi:[1,0,1]
  v_pk_fma_f32 v[164:165], v[122:123], v[140:141], v[10:11] op_sel_hi:[1,0,1]
  v_pk_fma_f32 v[168:169], v[120:121], v[144:145], v[36:37] op_sel_hi:[1,0,1]
  v_pk_fma_f32 v[172:173], v[122:123], v[144:145], v[38:39] op_sel_hi:[1,0,1]
  v_pk_mul_f32 v[162:163], v[160:161], v[142:143] op_sel_hi:[1,0]
  v_pk_mul_f32 v[166:167], v[164:165], v[142:143] op_sel_hi:[1,0]
  v_pk_mul_f32 v[170:171], v[168:169], v[146:147] op_sel_hi:[1,0]
  v_pk_mul_f32 v[174:175], v[172:173], v[146:147] op_sel_hi:[1,0]
  v_exp_f32 v162, v162
  v_exp_f32 v166, v166
  v_exp_f32 v170, v170
  v_exp_f32 v174, v174
  v_exp_f32 v163, v163
  v_exp_f32 v167, v167
  v_exp_f32 v171, v171
  v_exp_f32 v175, v175
  v_pk_mul_f32 v[160:161], v[160:161], v[140:141] op_sel:[0,1] op_sel_hi:[1,1]
  v_pk_mul_f32 v[164:165], v[164:165], v[140:141] op_sel:[0,1] op_sel_hi:[1,1]
  v_pk_mul_f32 v[168:169], v[168:169], v[144:145] op_sel:[0,1] op_sel_hi:[1,1]
  v_pk_mul_f32 v[172:173], v[172:173], v[144:145] op_sel:[0,1] op_sel_hi:[1,1]
  v_pk_add_f32 v[162:163], v[162:163], 1.0 op_sel_hi:[1,0]
  v_pk_add_f32 v[166:167], v[166:167], 1.0 op_sel_hi:[1,0]
  v_pk_add_f32 v[170:171], v[170:171], 1.0 op_sel_hi:[1,0]
  v_pk_add_f32 v[174:175], v[174:175], 1.0 op_sel_hi:[1,0]
  v_rcp_f32 v162, v162
  v_rcp_f32 v166, v166
  v_rcp_f32 v170, v170
  v_rcp_f32 v174, v174
  v_rcp_f32 v163, v163
  v_rcp_f32 v167, v167
  v_rcp_f32 v171, v171
  v_rcp_f32 v175, v175
  v_pk_mul_f32 v[160:161], v[160:161], v[162:163]
  v_pk_mul_f32 v[164:165], v[164:165], v[166:167]
  v_pk_mul_f32 v[168:169], v[168:169], v[170:171]
  v_pk_mul_f32 v[172:173], v[172:173], v[174:175]
  v_cvt_pk_bf16_f32 v192, v160, v161
  v_cvt_pk_bf16_f32 v193, v164, v165
  v_cvt_pk_bf16_f32 v194, v168, v169
  v_cvt_pk_bf16_f32 v195, v172, v173
  buffer_store_dwordx2 v[192:193], v230, s[32:35], s82 offen offset:0 sc1
  buffer_store_dwordx2 v[194:195], v230, s[32:35], s82 offen offset:512 sc1
  v_pk_fma_f32 v[176:177], v[120:121], v[148:149], v[64:65] op_sel_hi:[1,0,1]
  v_pk_fma_f32 v[180:181], v[122:123], v[148:149], v[66:67] op_sel_hi:[1,0,1]
  v_pk_fma_f32 v[184:185], v[120:121], v[152:153], v[92:93] op_sel_hi:[1,0,1]
  v_pk_fma_f32 v[188:189], v[122:123], v[152:153], v[94:95] op_sel_hi:[1,0,1]
  v_pk_mul_f32 v[178:179], v[176:177], v[150:151] op_sel_hi:[1,0]
  v_pk_mul_f32 v[182:183], v[180:181], v[150:151] op_sel_hi:[1,0]
  v_pk_mul_f32 v[186:187], v[184:185], v[154:155] op_sel_hi:[1,0]
  v_pk_mul_f32 v[190:191], v[188:189], v[154:155] op_sel_hi:[1,0]
  v_exp_f32 v178, v178
  v_exp_f32 v182, v182
  v_exp_f32 v186, v186
  v_exp_f32 v190, v190
  v_exp_f32 v179, v179
  v_exp_f32 v183, v183
  v_exp_f32 v187, v187
  v_exp_f32 v191, v191
  v_pk_mul_f32 v[176:177], v[176:177], v[148:149] op_sel:[0,1] op_sel_hi:[1,1]
  v_pk_mul_f32 v[180:181], v[180:181], v[148:149] op_sel:[0,1] op_sel_hi:[1,1]
  v_pk_mul_f32 v[184:185], v[184:185], v[152:153] op_sel:[0,1] op_sel_hi:[1,1]
  v_pk_mul_f32 v[188:189], v[188:189], v[152:153] op_sel:[0,1] op_sel_hi:[1,1]
  v_pk_add_f32 v[178:179], v[178:179], 1.0 op_sel_hi:[1,0]
  v_pk_add_f32 v[182:183], v[182:183], 1.0 op_sel_hi:[1,0]
  v_pk_add_f32 v[186:187], v[186:187], 1.0 op_sel_hi:[1,0]
  v_pk_add_f32 v[190:191], v[190:191], 1.0 op_sel_hi:[1,0]
  v_rcp_f32 v178, v178
  v_rcp_f32 v182, v182
  v_rcp_f32 v186, v186
  v_rcp_f32 v190, v190
  v_rcp_f32 v179, v179
  v_rcp_f32 v183, v183
  v_rcp_f32 v187, v187
  v_rcp_f32 v191, v191
  v_pk_mul_f32 v[176:177], v[176:177], v[178:179]
  v_pk_mul_f32 v[180:181], v[180:181], v[182:183]
  v_pk_mul_f32 v[184:185], v[184:185], v[186:187]
  v_pk_mul_f32 v[188:189], v[188:189], v[190:191]
  v_cvt_pk_bf16_f32 v196, v176, v177
  v_cvt_pk_bf16_f32 v197, v180, v181
  v_cvt_pk_bf16_f32 v198, v184, v185
  v_cvt_pk_bf16_f32 v199, v188, v189
  buffer_store_dwordx2 v[196:197], v230, s[32:35], s82 offen offset:1024 sc1
  buffer_store_dwordx2 v[198:199], v230, s[32:35], s82 offen offset:1536 sc1
  v_pk_fma_f32 v[160:161], v[124:125], v[140:141], v[12:13] op_sel_hi:[1,0,1]
  v_pk_fma_f32 v[164:165], v[126:127], v[140:141], v[14:15] op_sel_hi:[1,0,1]
  v_pk_fma_f32 v[168:169], v[124:125], v[144:145], v[40:41] op_sel_hi:[1,0,1]
  v_pk_fma_f32 v[172:173], v[126:127], v[144:145], v[42:43] op_sel_hi:[1,0,1]
  v_pk_mul_f32 v[162:163], v[160:161], v[142:143] op_sel_hi:[1,0]
  v_pk_mul_f32 v[166:167], v[164:165], v[142:143] op_sel_hi:[1,0]
  v_pk_mul_f32 v[170:171], v[168:169], v[146:147] op_sel_hi:[1,0]
  v_pk_mul_f32 v[174:175], v[172:173], v[146:147] op_sel_hi:[1,0]
  v_exp_f32 v162, v162
  v_exp_f32 v166, v166
  v_exp_f32 v170, v170
  v_exp_f32 v174, v174
  v_exp_f32 v163, v163
  v_exp_f32 v167, v167
  v_exp_f32 v171, v171
  v_exp_f32 v175, v175
  v_pk_mul_f32 v[160:161], v[160:161], v[140:141] op_sel:[0,1] op_sel_hi:[1,1]
  v_pk_mul_f32 v[164:165], v[164:165], v[140:141] op_sel:[0,1] op_sel_hi:[1,1]
  v_pk_mul_f32 v[168:169], v[168:169], v[144:145] op_sel:[0,1] op_sel_hi:[1,1]
  v_pk_mul_f32 v[172:173], v[172:173], v[144:145] op_sel:[0,1] op_sel_hi:[1,1]
  v_pk_add_f32 v[162:163], v[162:163], 1.0 op_sel_hi:[1,0]
  v_pk_add_f32 v[166:167], v[166:167], 1.0 op_sel_hi:[1,0]
  v_pk_add_f32 v[170:171], v[170:171], 1.0 op_sel_hi:[1,0]
  v_pk_add_f32 v[174:175], v[174:175], 1.0 op_sel_hi:[1,0]
  v_rcp_f32 v162, v162
  v_rcp_f32 v166, v166
  v_rcp_f32 v170, v170
  v_rcp_f32 v174, v174
  v_rcp_f32 v163, v163
  v_rcp_f32 v167, v167
  v_rcp_f32 v171, v171
  v_rcp_f32 v175, v175
  v_pk_mul_f32 v[160:161], v[160:161], v[162:163]
  v_pk_mul_f32 v[164:165], v[164:165], v[166:167]
  v_pk_mul_f32 v[168:169], v[168:169], v[170:171]
  v_pk_mul_f32 v[172:173], v[172:173], v[174:175]
  v_cvt_pk_bf16_f32 v192, v160, v161
  v_cvt_pk_bf16_f32 v193, v164, v165
  v_cvt_pk_bf16_f32 v194, v168, v169
  v_cvt_pk_bf16_f32 v195, v172, v173
  buffer_store_dwordx2 v[192:193], v230, s[32:35], s83 offen offset:0 sc1
  buffer_store_dwordx2 v[194:195], v230, s[32:35], s83 offen offset:512 sc1
  v_pk_fma_f32 v[176:177], v[124:125], v[148:149], v[68:69] op_sel_hi:[1,0,1]
  v_pk_fma_f32 v[180:181], v[126:127], v[148:149], v[70:71] op_sel_hi:[1,0,1]
  v_pk_fma_f32 v[184:185], v[124:125], v[152:153], v[96:97] op_sel_hi:[1,0,1]
  v_pk_fma_f32 v[188:189], v[126:127], v[152:153], v[98:99] op_sel_hi:[1,0,1]
  v_pk_mul_f32 v[178:179], v[176:177], v[150:151] op_sel_hi:[1,0]
  v_pk_mul_f32 v[182:183], v[180:181], v[150:151] op_sel_hi:[1,0]
  v_pk_mul_f32 v[186:187], v[184:185], v[154:155] op_sel_hi:[1,0]
  v_pk_mul_f32 v[190:191], v[188:189], v[154:155] op_sel_hi:[1,0]
  v_exp_f32 v178, v178
  v_exp_f32 v182, v182
  v_exp_f32 v186, v186
  v_exp_f32 v190, v190
  v_exp_f32 v179, v179
  v_exp_f32 v183, v183
  v_exp_f32 v187, v187
  v_exp_f32 v191, v191
  v_pk_mul_f32 v[176:177], v[176:177], v[148:149] op_sel:[0,1] op_sel_hi:[1,1]
  v_pk_mul_f32 v[180:181], v[180:181], v[148:149] op_sel:[0,1] op_sel_hi:[1,1]
  v_pk_mul_f32 v[184:185], v[184:185], v[152:153] op_sel:[0,1] op_sel_hi:[1,1]
  v_pk_mul_f32 v[188:189], v[188:189], v[152:153] op_sel:[0,1] op_sel_hi:[1,1]
  v_pk_add_f32 v[178:179], v[178:179], 1.0 op_sel_hi:[1,0]
  v_pk_add_f32 v[182:183], v[182:183], 1.0 op_sel_hi:[1,0]
  v_pk_add_f32 v[186:187], v[186:187], 1.0 op_sel_hi:[1,0]
  v_pk_add_f32 v[190:191], v[190:191], 1.0 op_sel_hi:[1,0]
  v_rcp_f32 v178, v178
  v_rcp_f32 v182, v182
  v_rcp_f32 v186, v186
  v_rcp_f32 v190, v190
  v_rcp_f32 v179, v179
  v_rcp_f32 v183, v183
  v_rcp_f32 v187, v187
  v_rcp_f32 v191, v191
  v_pk_mul_f32 v[176:177], v[176:177], v[178:179]
  v_pk_mul_f32 v[180:181], v[180:181], v[182:183]
  v_pk_mul_f32 v[184:185], v[184:185], v[186:187]
  v_pk_mul_f32 v[188:189], v[188:189], v[190:191]
  v_cvt_pk_bf16_f32 v196, v176, v177
  v_cvt_pk_bf16_f32 v197, v180, v181
  v_cvt_pk_bf16_f32 v198, v184, v185
  v_cvt_pk_bf16_f32 v199, v188, v189
  buffer_store_dwordx2 v[196:197], v230, s[32:35], s83 offen offset:1024 sc1
  buffer_store_dwordx2 v[198:199], v230, s[32:35], s83 offen offset:1536 sc1
  v_pk_fma_f32 v[160:161], v[128:129], v[140:141], v[16:17] op_sel_hi:[1,0,1]
  v_pk_fma_f32 v[164:165], v[130:131], v[140:141], v[18:19] op_sel_hi:[1,0,1]
  v_pk_fma_f32 v[168:169], v[128:129], v[144:145], v[44:45] op_sel_hi:[1,0,1]
  v_pk_fma_f32 v[172:173], v[130:131], v[144:145], v[46:47] op_sel_hi:[1,0,1]
  v_pk_mul_f32 v[162:163], v[160:161], v[142:143] op_sel_hi:[1,0]
  v_pk_mul_f32 v[166:167], v[164:165], v[142:143] op_sel_hi:[1,0]
  v_pk_mul_f32 v[170:171], v[168:169], v[146:147] op_sel_hi:[1,0]
  v_pk_mul_f32 v[174:175], v[172:173], v[146:147] op_sel_hi:[1,0]
  v_exp_f32 v162, v162
  v_exp_f32 v166, v166
  v_exp_f32 v170, v170
  v_exp_f32 v174, v174
  v_exp_f32 v163, v163
  v_exp_f32 v167, v167
  v_exp_f32 v171, v171
  v_exp_f32 v175, v175
  v_pk_mul_f32 v[160:161], v[160:161], v[140:141] op_sel:[0,1] op_sel_hi:[1,1]
  v_pk_mul_f32 v[164:165], v[164:165], v[140:141] op_sel:[0,1] op_sel_hi:[1,1]
  v_pk_mul_f32 v[168:169], v[168:169], v[144:145] op_sel:[0,1] op_sel_hi:[1,1]
  v_pk_mul_f32 v[172:173], v[172:173], v[144:145] op_sel:[0,1] op_sel_hi:[1,1]
  v_pk_add_f32 v[162:163], v[162:163], 1.0 op_sel_hi:[1,0]
  v_pk_add_f32 v[166:167], v[166:167], 1.0 op_sel_hi:[1,0]
  v_pk_add_f32 v[170:171], v[170:171], 1.0 op_sel_hi:[1,0]
  v_pk_add_f32 v[174:175], v[174:175], 1.0 op_sel_hi:[1,0]
  v_rcp_f32 v162, v162
  v_rcp_f32 v166, v166
  v_rcp_f32 v170, v170
  v_rcp_f32 v174, v174
  v_rcp_f32 v163, v163
  v_rcp_f32 v167, v167
  v_rcp_f32 v171, v171
  v_rcp_f32 v175, v175
  v_pk_mul_f32 v[160:161], v[160:161], v[162:163]
  v_pk_mul_f32 v[164:165], v[164:165], v[166:167]
  v_pk_mul_f32 v[168:169], v[168:169], v[170:171]
  v_pk_mul_f32 v[172:173], v[172:173], v[174:175]
  v_cvt_pk_bf16_f32 v192, v160, v161
  v_cvt_pk_bf16_f32 v193, v164, v165
  v_cvt_pk_bf16_f32 v194, v168, v169
  v_cvt_pk_bf16_f32 v195, v172, v173
  buffer_store_dwordx2 v[192:193], v230, s[32:35], s84 offen offset:0 sc1
  buffer_store_dwordx2 v[194:195], v230, s[32:35], s84 offen offset:512 sc1
  v_pk_fma_f32 v[176:177], v[128:129], v[148:149], v[72:73] op_sel_hi:[1,0,1]
  v_pk_fma_f32 v[180:181], v[130:131], v[148:149], v[74:75] op_sel_hi:[1,0,1]
  v_pk_fma_f32 v[184:185], v[128:129], v[152:153], v[100:101] op_sel_hi:[1,0,1]
  v_pk_fma_f32 v[188:189], v[130:131], v[152:153], v[102:103] op_sel_hi:[1,0,1]
  v_pk_mul_f32 v[178:179], v[176:177], v[150:151] op_sel_hi:[1,0]
  v_pk_mul_f32 v[182:183], v[180:181], v[150:151] op_sel_hi:[1,0]
  v_pk_mul_f32 v[186:187], v[184:185], v[154:155] op_sel_hi:[1,0]
  v_pk_mul_f32 v[190:191], v[188:189], v[154:155] op_sel_hi:[1,0]
  v_exp_f32 v178, v178
  v_exp_f32 v182, v182
  v_exp_f32 v186, v186
  v_exp_f32 v190, v190
  v_exp_f32 v179, v179
  v_exp_f32 v183, v183
  v_exp_f32 v187, v187
  v_exp_f32 v191, v191
  v_pk_mul_f32 v[176:177], v[176:177], v[148:149] op_sel:[0,1] op_sel_hi:[1,1]
  v_pk_mul_f32 v[180:181], v[180:181], v[148:149] op_sel:[0,1] op_sel_hi:[1,1]
  v_pk_mul_f32 v[184:185], v[184:185], v[152:153] op_sel:[0,1] op_sel_hi:[1,1]
  v_pk_mul_f32 v[188:189], v[188:189], v[152:153] op_sel:[0,1] op_sel_hi:[1,1]
  v_pk_add_f32 v[178:179], v[178:179], 1.0 op_sel_hi:[1,0]
  v_pk_add_f32 v[182:183], v[182:183], 1.0 op_sel_hi:[1,0]
  v_pk_add_f32 v[186:187], v[186:187], 1.0 op_sel_hi:[1,0]
  v_pk_add_f32 v[190:191], v[190:191], 1.0 op_sel_hi:[1,0]
  v_rcp_f32 v178, v178
  v_rcp_f32 v182, v182
  v_rcp_f32 v186, v186
  v_rcp_f32 v190, v190
  v_rcp_f32 v179, v179
  v_rcp_f32 v183, v183
  v_rcp_f32 v187, v187
  v_rcp_f32 v191, v191
  v_pk_mul_f32 v[176:177], v[176:177], v[178:179]
  v_pk_mul_f32 v[180:181], v[180:181], v[182:183]
  v_pk_mul_f32 v[184:185], v[184:185], v[186:187]
  v_pk_mul_f32 v[188:189], v[188:189], v[190:191]
  v_cvt_pk_bf16_f32 v196, v176, v177
  v_cvt_pk_bf16_f32 v197, v180, v181
  v_cvt_pk_bf16_f32 v198, v184, v185
  v_cvt_pk_bf16_f32 v199, v188, v189
  buffer_store_dwordx2 v[196:197], v230, s[32:35], s84 offen offset:1024 sc1
  buffer_store_dwordx2 v[198:199], v230, s[32:35], s84 offen offset:1536 sc1
  v_pk_fma_f32 v[160:161], v[132:133], v[140:141], v[20:21] op_sel_hi:[1,0,1]
  v_pk_fma_f32 v[164:165], v[134:135], v[140:141], v[22:23] op_sel_hi:[1,0,1]
  v_pk_fma_f32 v[168:169], v[132:133], v[144:145], v[48:49] op_sel_hi:[1,0,1]
  v_pk_fma_f32 v[172:173], v[134:135], v[144:145], v[50:51] op_sel_hi:[1,0,1]
  v_pk_mul_f32 v[162:163], v[160:161], v[142:143] op_sel_hi:[1,0]
  v_pk_mul_f32 v[166:167], v[164:165], v[142:143] op_sel_hi:[1,0]
  v_pk_mul_f32 v[170:171], v[168:169], v[146:147] op_sel_hi:[1,0]
  v_pk_mul_f32 v[174:175], v[172:173], v[146:147] op_sel_hi:[1,0]
  v_exp_f32 v162, v162
  v_exp_f32 v166, v166
  v_exp_f32 v170, v170
  v_exp_f32 v174, v174
  v_exp_f32 v163, v163
  v_exp_f32 v167, v167
  v_exp_f32 v171, v171
  v_exp_f32 v175, v175
  v_pk_mul_f32 v[160:161], v[160:161], v[140:141] op_sel:[0,1] op_sel_hi:[1,1]
  v_pk_mul_f32 v[164:165], v[164:165], v[140:141] op_sel:[0,1] op_sel_hi:[1,1]
  v_pk_mul_f32 v[168:169], v[168:169], v[144:145] op_sel:[0,1] op_sel_hi:[1,1]
  v_pk_mul_f32 v[172:173], v[172:173], v[144:145] op_sel:[0,1] op_sel_hi:[1,1]
  v_pk_add_f32 v[162:163], v[162:163], 1.0 op_sel_hi:[1,0]
  v_pk_add_f32 v[166:167], v[166:167], 1.0 op_sel_hi:[1,0]
  v_pk_add_f32 v[170:171], v[170:171], 1.0 op_sel_hi:[1,0]
  v_pk_add_f32 v[174:175], v[174:175], 1.0 op_sel_hi:[1,0]
  v_rcp_f32 v162, v162
  v_rcp_f32 v166, v166
  v_rcp_f32 v170, v170
  v_rcp_f32 v174, v174
  v_rcp_f32 v163, v163
  v_rcp_f32 v167, v167
  v_rcp_f32 v171, v171
  v_rcp_f32 v175, v175
  v_pk_mul_f32 v[160:161], v[160:161], v[162:163]
  v_pk_mul_f32 v[164:165], v[164:165], v[166:167]
  v_pk_mul_f32 v[168:169], v[168:169], v[170:171]
  v_pk_mul_f32 v[172:173], v[172:173], v[174:175]
  v_cvt_pk_bf16_f32 v192, v160, v161
  v_cvt_pk_bf16_f32 v193, v164, v165
  v_cvt_pk_bf16_f32 v194, v168, v169
  v_cvt_pk_bf16_f32 v195, v172, v173
  buffer_store_dwordx2 v[192:193], v230, s[32:35], s85 offen offset:0 sc1
  buffer_store_dwordx2 v[194:195], v230, s[32:35], s85 offen offset:512 sc1
  v_pk_fma_f32 v[176:177], v[132:133], v[148:149], v[76:77] op_sel_hi:[1,0,1]
  v_pk_fma_f32 v[180:181], v[134:135], v[148:149], v[78:79] op_sel_hi:[1,0,1]
  v_pk_fma_f32 v[184:185], v[132:133], v[152:153], v[104:105] op_sel_hi:[1,0,1]
  v_pk_fma_f32 v[188:189], v[134:135], v[152:153], v[106:107] op_sel_hi:[1,0,1]
  v_pk_mul_f32 v[178:179], v[176:177], v[150:151] op_sel_hi:[1,0]
  v_pk_mul_f32 v[182:183], v[180:181], v[150:151] op_sel_hi:[1,0]
  v_pk_mul_f32 v[186:187], v[184:185], v[154:155] op_sel_hi:[1,0]
  v_pk_mul_f32 v[190:191], v[188:189], v[154:155] op_sel_hi:[1,0]
  v_exp_f32 v178, v178
  v_exp_f32 v182, v182
  v_exp_f32 v186, v186
  v_exp_f32 v190, v190
  v_exp_f32 v179, v179
  v_exp_f32 v183, v183
  v_exp_f32 v187, v187
  v_exp_f32 v191, v191
  v_pk_mul_f32 v[176:177], v[176:177], v[148:149] op_sel:[0,1] op_sel_hi:[1,1]
  v_pk_mul_f32 v[180:181], v[180:181], v[148:149] op_sel:[0,1] op_sel_hi:[1,1]
  v_pk_mul_f32 v[184:185], v[184:185], v[152:153] op_sel:[0,1] op_sel_hi:[1,1]
  v_pk_mul_f32 v[188:189], v[188:189], v[152:153] op_sel:[0,1] op_sel_hi:[1,1]
  v_pk_add_f32 v[178:179], v[178:179], 1.0 op_sel_hi:[1,0]
  v_pk_add_f32 v[182:183], v[182:183], 1.0 op_sel_hi:[1,0]
  v_pk_add_f32 v[186:187], v[186:187], 1.0 op_sel_hi:[1,0]
  v_pk_add_f32 v[190:191], v[190:191], 1.0 op_sel_hi:[1,0]
  v_rcp_f32 v178, v178
  v_rcp_f32 v182, v182
  v_rcp_f32 v186, v186
  v_rcp_f32 v190, v190
  v_rcp_f32 v179, v179
  v_rcp_f32 v183, v183
  v_rcp_f32 v187, v187
  v_rcp_f32 v191, v191
  v_pk_mul_f32 v[176:177], v[176:177], v[178:179]
  v_pk_mul_f32 v[180:181], v[180:181], v[182:183]
  v_pk_mul_f32 v[184:185], v[184:185], v[186:187]
  v_pk_mul_f32 v[188:189], v[188:189], v[190:191]
  v_cvt_pk_bf16_f32 v196, v176, v177
  v_cvt_pk_bf16_f32 v197, v180, v181
  v_cvt_pk_bf16_f32 v198, v184, v185
  v_cvt_pk_bf16_f32 v199, v188, v189
  buffer_store_dwordx2 v[196:197], v230, s[32:35], s85 offen offset:1024 sc1
  buffer_store_dwordx2 v[198:199], v230, s[32:35], s85 offen offset:1536 sc1
  v_pk_fma_f32 v[160:161], v[136:137], v[140:141], v[24:25] op_sel_hi:[1,0,1]
  v_pk_fma_f32 v[164:165], v[138:139], v[140:141], v[26:27] op_sel_hi:[1,0,1]
  v_pk_fma_f32 v[168:169], v[136:137], v[144:145], v[52:53] op_sel_hi:[1,0,1]
  v_pk_fma_f32 v[172:173], v[138:139], v[144:145], v[54:55] op_sel_hi:[1,0,1]
  v_pk_mul_f32 v[162:163], v[160:161], v[142:143] op_sel_hi:[1,0]
  v_pk_mul_f32 v[166:167], v[164:165], v[142:143] op_sel_hi:[1,0]
  v_pk_mul_f32 v[170:171], v[168:169], v[146:147] op_sel_hi:[1,0]
  v_pk_mul_f32 v[174:175], v[172:173], v[146:147] op_sel_hi:[1,0]
  v_exp_f32 v162, v162
  v_exp_f32 v166, v166
  v_exp_f32 v170, v170
  v_exp_f32 v174, v174
  v_exp_f32 v163, v163
  v_exp_f32 v167, v167
  v_exp_f32 v171, v171
  v_exp_f32 v175, v175
  v_pk_mul_f32 v[160:161], v[160:161], v[140:141] op_sel:[0,1] op_sel_hi:[1,1]
  v_pk_mul_f32 v[164:165], v[164:165], v[140:141] op_sel:[0,1] op_sel_hi:[1,1]
  v_pk_mul_f32 v[168:169], v[168:169], v[144:145] op_sel:[0,1] op_sel_hi:[1,1]
  v_pk_mul_f32 v[172:173], v[172:173], v[144:145] op_sel:[0,1] op_sel_hi:[1,1]
  v_pk_add_f32 v[162:163], v[162:163], 1.0 op_sel_hi:[1,0]
  v_pk_add_f32 v[166:167], v[166:167], 1.0 op_sel_hi:[1,0]
  v_pk_add_f32 v[170:171], v[170:171], 1.0 op_sel_hi:[1,0]
  v_pk_add_f32 v[174:175], v[174:175], 1.0 op_sel_hi:[1,0]
  v_rcp_f32 v162, v162
  v_rcp_f32 v166, v166
  v_rcp_f32 v170, v170
  v_rcp_f32 v174, v174
  v_rcp_f32 v163, v163
  v_rcp_f32 v167, v167
  v_rcp_f32 v171, v171
  v_rcp_f32 v175, v175
  v_pk_mul_f32 v[160:161], v[160:161], v[162:163]
  v_pk_mul_f32 v[164:165], v[164:165], v[166:167]
  v_pk_mul_f32 v[168:169], v[168:169], v[170:171]
  v_pk_mul_f32 v[172:173], v[172:173], v[174:175]
  v_cvt_pk_bf16_f32 v192, v160, v161
  v_cvt_pk_bf16_f32 v193, v164, v165
  v_cvt_pk_bf16_f32 v194, v168, v169
  v_cvt_pk_bf16_f32 v195, v172, v173
  buffer_store_dwordx2 v[192:193], v230, s[32:35], s86 offen offset:0 sc1
  buffer_store_dwordx2 v[194:195], v230, s[32:35], s86 offen offset:512 sc1
  v_pk_fma_f32 v[176:177], v[136:137], v[148:149], v[80:81] op_sel_hi:[1,0,1]
  v_pk_fma_f32 v[180:181], v[138:139], v[148:149], v[82:83] op_sel_hi:[1,0,1]
  v_pk_fma_f32 v[184:185], v[136:137], v[152:153], v[108:109] op_sel_hi:[1,0,1]
  v_pk_fma_f32 v[188:189], v[138:139], v[152:153], v[110:111] op_sel_hi:[1,0,1]
  v_pk_mul_f32 v[178:179], v[176:177], v[150:151] op_sel_hi:[1,0]
  v_pk_mul_f32 v[182:183], v[180:181], v[150:151] op_sel_hi:[1,0]
  v_pk_mul_f32 v[186:187], v[184:185], v[154:155] op_sel_hi:[1,0]
  v_pk_mul_f32 v[190:191], v[188:189], v[154:155] op_sel_hi:[1,0]
  v_exp_f32 v178, v178
  v_exp_f32 v182, v182
  v_exp_f32 v186, v186
  v_exp_f32 v190, v190
  v_exp_f32 v179, v179
  v_exp_f32 v183, v183
  v_exp_f32 v187, v187
  v_exp_f32 v191, v191
  v_pk_mul_f32 v[176:177], v[176:177], v[148:149] op_sel:[0,1] op_sel_hi:[1,1]
  v_pk_mul_f32 v[180:181], v[180:181], v[148:149] op_sel:[0,1] op_sel_hi:[1,1]
  v_pk_mul_f32 v[184:185], v[184:185], v[152:153] op_sel:[0,1] op_sel_hi:[1,1]
  v_pk_mul_f32 v[188:189], v[188:189], v[152:153] op_sel:[0,1] op_sel_hi:[1,1]
  v_pk_add_f32 v[178:179], v[178:179], 1.0 op_sel_hi:[1,0]
  v_pk_add_f32 v[182:183], v[182:183], 1.0 op_sel_hi:[1,0]
  v_pk_add_f32 v[186:187], v[186:187], 1.0 op_sel_hi:[1,0]
  v_pk_add_f32 v[190:191], v[190:191], 1.0 op_sel_hi:[1,0]
  v_rcp_f32 v178, v178
  v_rcp_f32 v182, v182
  v_rcp_f32 v186, v186
  v_rcp_f32 v190, v190
  v_rcp_f32 v179, v179
  v_rcp_f32 v183, v183
  v_rcp_f32 v187, v187
  v_rcp_f32 v191, v191
  v_pk_mul_f32 v[176:177], v[176:177], v[178:179]
  v_pk_mul_f32 v[180:181], v[180:181], v[182:183]
  v_pk_mul_f32 v[184:185], v[184:185], v[186:187]
  v_pk_mul_f32 v[188:189], v[188:189], v[190:191]
  v_cvt_pk_bf16_f32 v196, v176, v177
  v_cvt_pk_bf16_f32 v197, v180, v181
  v_cvt_pk_bf16_f32 v198, v184, v185
  v_cvt_pk_bf16_f32 v199, v188, v189
  buffer_store_dwordx2 v[196:197], v230, s[32:35], s86 offen offset:1024 sc1
  buffer_store_dwordx2 v[198:199], v230, s[32:35], s86 offen offset:1536 sc1
  s_waitcnt vmcnt(0)
  s_barrier
  s_lshl_b32 s61, s48, 5
  v_and_b32 v240, 15, v255
  v_add_u32 v240, s61, v240
  v_lshlrev_b32 v240, 5, v240
  v_lshrrev_b32 v241, 5, v255
  v_lshl_add_u32 v240, v241, 12, v240
  v_bfe_u32 v241, v255, 4, 1
  v_lshl_add_u32 v236, v241, 4, v240
  v_lshrrev_b32 v240, 4, v255
  v_bfe_u32 v241, v255, 2, 2
  v_lshl_add_u32 v239, v240, 3, v241
  v_lshlrev_b32 v239, 7, v239
  v_and_b32 v242, 3, v255
  v_lshl_add_u32 v239, v242, 3, v239
  v_add_u32 v239, 16384, v239
  v_and_b32 v240, 1, v240
  v_lshlrev_b32 v240, 1, v240
  v_lshrrev_b32 v241, 1, v241
  v_or_b32 v238, v240, v241
  v_xor_b32 v240, 0, v238
  v_lshl_add_u32 v232, v240, 5, v239
  v_xor_b32 v240, 1, v238
  v_lshl_add_u32 v233, v240, 5, v239
  v_xor_b32 v240, 2, v238
  v_lshl_add_u32 v234, v240, 5, v239
  v_xor_b32 v240, 3, v238
  v_lshl_add_u32 v235, v240, 5, v239
  v_and_b32 v240, 15, v255
  v_add_u32 v240, s61, v240
  v_lshrrev_b32 v241, 4, v255
  v_lshlrev_b32 v230, 5, v240
  v_lshl_add_u32 v230, v241, 3, v230
  v_lshlrev_b32 v231, 3, v240
  s_lshl_b32 s80, s75, 2
  s_add_u32 s80, s80, 0
  s_lshl_b32 s80, s80, 12
  s_lshl_b32 s81, s75, 2
  s_add_u32 s81, s81, 1
  s_lshl_b32 s81, s81, 12
  s_lshl_b32 s82, s75, 2
  s_add_u32 s82, s82, 2
  s_lshl_b32 s82, s82, 12
  s_lshl_b32 s83, s75, 2
  s_add_u32 s83, s83, 3
  s_lshl_b32 s83, s83, 12
  s_mul_i32 s59, s74, 262144
  s_add_u32 s36, s20, 4194304
  s_addc_u32 s37, s21, 0
  s_add_u32 s36, s36, s59
  s_addc_u32 s37, s37, 0
  s_mov_b32 s38, 262144
  s_mov_b32 s39, 0x00020000
  buffer_load_dwordx2 v[96:97], v230, s[36:39], s80 offen offset:0 sc1
  buffer_load_dwordx2 v[98:99], v230, s[36:39], s81 offen offset:0 sc1
  buffer_load_dwordx2 v[100:101], v230, s[36:39], s82 offen offset:0 sc1
  buffer_load_dwordx2 v[102:103], v230, s[36:39], s83 offen offset:0 sc1
  buffer_load_dwordx2 v[104:105], v230, s[36:39], s80 offen offset:512 sc1
  buffer_load_dwordx2 v[106:107], v230, s[36:39], s81 offen offset:512 sc1
  buffer_load_dwordx2 v[108:109], v230, s[36:39], s82 offen offset:512 sc1
  buffer_load_dwordx2 v[110:111], v230, s[36:39], s83 offen offset:512 sc1
  s_add_u32 s32, s20, 8388608
  s_addc_u32 s33, s21, 0
  s_add_u32 s32, s32, s59
  s_addc_u32 s33, s33, 0
  s_mov_b32 s34, 262144
  s_mov_b32 s35, 0x00020000
  s_mov_b32 s60, 34078720
  s_lshl_b32 s59, s75, 14
  s_add_u32 s60, s60, s59
  s_lshl_b32 s59, s74, 10
  s_add_u32 s60, s60, s59
  s_add_u32 s40, s20, s60
  s_addc_u32 s41, s21, 0
  s_mov_b32 s42, 1024
  s_mov_b32 s43, 0x00020000
  v_mov_b32 v0, 0
  v_mov_b32 v1, 0
  v_mov_b32 v2, 0
  v_mov_b32 v3, 0
  v_mov_b32 v4, 0
  v_mov_b32 v5, 0
  v_mov_b32 v6, 0
  v_mov_b32 v7, 0
  v_mov_b32 v8, 0
  v_mov_b32 v9, 0
  v_mov_b32 v10, 0
  v_mov_b32 v11, 0
  v_mov_b32 v12, 0
  v_mov_b32 v13, 0
  v_mov_b32 v14, 0
  v_mov_b32 v15, 0
  v_mov_b32 v16, 0
  v_mov_b32 v17, 0
  v_mov_b32 v18, 0
  v_mov_b32 v19, 0
  v_mov_b32 v20, 0
  v_mov_b32 v21, 0
  v_mov_b32 v22, 0
  v_mov_b32 v23, 0
  v_mov_b32 v24, 0
  v_mov_b32 v25, 0
  v_mov_b32 v26, 0
  v_mov_b32 v27, 0
  v_mov_b32 v28, 0
  v_mov_b32 v29, 0
  v_mov_b32 v30, 0
  v_mov_b32 v31, 0
  s_mov_b32 s53, 56
  s_mov_b32 s51, 24576
  s_mov_b32 s62, 24576
  s_barrier
  ds_read_b128 v[32:35], v236 offset:0
  ds_read_b128 v[36:39], v236 offset:512
  ds_read_b64_tr_b16 v[48:49], v232 offset:0
  ds_read_b64_tr_b16 v[50:51], v232 offset:512
  ds_read_b64_tr_b16 v[52:53], v233 offset:0
  ds_read_b64_tr_b16 v[54:55], v233 offset:512
  ds_read_b64_tr_b16 v[56:57], v234 offset:0
  ds_read_b64_tr_b16 v[58:59], v234 offset:512
  ds_read_b64_tr_b16 v[60:61], v235 offset:0
  ds_read_b64_tr_b16 v[62:63], v235 offset:512
  .p2align 3
L_cl_44:
  s_waitcnt lgkmcnt(0)
  v_mfma_f32_16x16x32_bf16 v[0:3], v[48:51], v[32:35], v[0:3]
  ds_read_b128 v[40:43], v236 offset:8192
  ds_read_b128 v[44:47], v236 offset:8704
  v_mfma_f32_16x16x32_bf16 v[16:19], v[48:51], v[36:39], v[16:19]
  ds_read_b64_tr_b16 v[64:65], v232 offset:4096
  ds_read_b64_tr_b16 v[66:67], v232 offset:4608
  v_mfma_f32_16x16x32_bf16 v[4:7], v[52:55], v[32:35], v[4:7]
  ds_read_b64_tr_b16 v[68:69], v233 offset:4096
  ds_read_b64_tr_b16 v[70:71], v233 offset:4608
  v_mfma_f32_16x16x32_bf16 v[20:23], v[52:55], v[36:39], v[20:23]
  ds_read_b64_tr_b16 v[72:73], v234 offset:4096
  ds_read_b64_tr_b16 v[74:75], v234 offset:4608
  v_mfma_f32_16x16x32_bf16 v[8:11], v[56:59], v[32:35], v[8:11]
  ds_read_b64_tr_b16 v[76:77], v235 offset:4096
  ds_read_b64_tr_b16 v[78:79], v235 offset:4608
  v_mfma_f32_16x16x32_bf16 v[24:27], v[56:59], v[36:39], v[24:27]
  v_add_u32 v236, s62, v236
  v_add_u32 v232, s62, v232
  v_mfma_f32_16x16x32_bf16 v[12:15], v[60:63], v[32:35], v[12:15]
  v_add_u32 v233, s62, v233
  v_add_u32 v234, s62, v234
  v_mfma_f32_16x16x32_bf16 v[28:31], v[60:63], v[36:39], v[28:31]
  v_add_u32 v235, s62, v235
  s_waitcnt lgkmcnt(0)
  v_mfma_f32_16x16x32_bf16 v[0:3], v[64:67], v[40:43], v[0:3]
  s_barrier
  v_mfma_f32_16x16x32_bf16 v[16:19], v[64:67], v[44:47], v[16:19]
  ds_read_b128 v[32:35], v236 offset:0
  ds_read_b128 v[36:39], v236 offset:512
  v_mfma_f32_16x16x32_bf16 v[4:7], v[68:71], v[40:43], v[4:7]
  ds_read_b64_tr_b16 v[48:49], v232 offset:0
  ds_read_b64_tr_b16 v[50:51], v232 offset:512
  v_mfma_f32_16x16x32_bf16 v[20:23], v[68:71], v[44:47], v[20:23]
  ds_read_b64_tr_b16 v[52:53], v233 offset:0
  ds_read_b64_tr_b16 v[54:55], v233 offset:512
  v_mfma_f32_16x16x32_bf16 v[8:11], v[72:75], v[40:43], v[8:11]
  ds_read_b64_tr_b16 v[56:57], v234 offset:0
  ds_read_b64_tr_b16 v[58:59], v234 offset:512
  v_mfma_f32_16x16x32_bf16 v[24:27], v[72:75], v[44:47], v[24:27]
  ds_read_b64_tr_b16 v[60:61], v235 offset:0
  ds_read_b64_tr_b16 v[62:63], v235 offset:512
  v_mfma_f32_16x16x32_bf16 v[12:15], v[76:79], v[40:43], v[12:15]
  s_add_u32 s52, s51, 24576
  s_cmp_eq_u32 s52, 98304
  v_mfma_f32_16x16x32_bf16 v[28:31], v[76:79], v[44:47], v[28:31]
  s_cselect_b32 s52, 0, s52
  s_sub_u32 s62, s52, s51
  s_mov_b32 s51, s52
  s_sub_u32 s53, s53, 1
  s_cmp_lg_u32 s53, 0
  s_cbranch_scc1 L_cl_44
  s_waitcnt lgkmcnt(0)
  s_nop 7
  s_nop 1
  s_waitcnt vmcnt(0)
  v_lshlrev_b32 v112, 16, v96
  v_and_b32 v113, 0xffff0000, v96
  v_lshlrev_b32 v114, 16, v97
  v_and_b32 v115, 0xffff0000, v97
  v_pk_add_f32 v[0:1], v[0:1], v[112:113]
  v_pk_add_f32 v[2:3], v[2:3], v[114:115]
  v_lshlrev_b32 v116, 16, v98
  v_and_b32 v117, 0xffff0000, v98
  v_lshlrev_b32 v118, 16, v99
  v_and_b32 v119, 0xffff0000, v99
  v_pk_add_f32 v[4:5], v[4:5], v[116:117]
  v_pk_add_f32 v[6:7], v[6:7], v[118:119]
  v_lshlrev_b32 v112, 16, v100
  v_and_b32 v113, 0xffff0000, v100
  v_lshlrev_b32 v114, 16, v101
  v_and_b32 v115, 0xffff0000, v101
  v_pk_add_f32 v[8:9], v[8:9], v[112:113]
  v_pk_add_f32 v[10:11], v[10:11], v[114:115]
  v_lshlrev_b32 v116, 16, v102
  v_and_b32 v117, 0xffff0000, v102
  v_lshlrev_b32 v118, 16, v103
  v_and_b32 v119, 0xffff0000, v103
  v_pk_add_f32 v[12:13], v[12:13], v[116:117]
  v_pk_add_f32 v[14:15], v[14:15], v[118:119]
  v_lshlrev_b32 v112, 16, v104
  v_and_b32 v113, 0xffff0000, v104
  v_lshlrev_b32 v114, 16, v105
  v_and_b32 v115, 0xffff0000, v105
  v_pk_add_f32 v[16:17], v[16:17], v[112:113]
  v_pk_add_f32 v[18:19], v[18:19], v[114:115]
  v_lshlrev_b32 v116, 16, v106
  v_and_b32 v117, 0xffff0000, v106
  v_lshlrev_b32 v118, 16, v107
  v_and_b32 v119, 0xffff0000, v107
  v_pk_add_f32 v[20:21], v[20:21], v[116:117]
  v_pk_add_f32 v[22:23], v[22:23], v[118:119]
  v_lshlrev_b32 v112, 16, v108
  v_and_b32 v113, 0xffff0000, v108
  v_lshlrev_b32 v114, 16, v109
  v_and_b32 v115, 0xffff0000, v109
  v_pk_add_f32 v[24:25], v[24:25], v[112:113]
  v_pk_add_f32 v[26:27], v[26:27], v[114:115]
  v_lshlrev_b32 v116, 16, v110
  v_and_b32 v117, 0xffff0000, v110
  v_lshlrev_b32 v118, 16, v111
  v_and_b32 v119, 0xffff0000, v111
  v_pk_add_f32 v[28:29], v[28:29], v[116:117]
  v_pk_add_f32 v[30:31], v[30:31], v[118:119]
  v_cvt_pk_bf16_f32 v64, v0, v1
  v_cvt_pk_bf16_f32 v65, v2, v3
  v_cvt_pk_bf16_f32 v66, v4, v5
  v_cvt_pk_bf16_f32 v67, v6, v7
  v_cvt_pk_bf16_f32 v68, v8, v9
  v_cvt_pk_bf16_f32 v69, v10, v11
  v_cvt_pk_bf16_f32 v70, v12, v13
  v_cvt_pk_bf16_f32 v71, v14, v15
  v_cvt_pk_bf16_f32 v72, v16, v17
  v_cvt_pk_bf16_f32 v73, v18, v19
  v_cvt_pk_bf16_f32 v74, v20, v21
  v_cvt_pk_bf16_f32 v75, v22, v23
  v_cvt_pk_bf16_f32 v76, v24, v25
  v_cvt_pk_bf16_f32 v77, v26, v27
  v_cvt_pk_bf16_f32 v78, v28, v29
  v_cvt_pk_bf16_f32 v79, v30, v31
  s_cmp_lg_u32 s71, 0
  s_cbranch_scc1 L_final_45
  buffer_store_dwordx2 v[64:65], v230, s[32:35], s80 offen offset:0 sc1
  buffer_store_dwordx2 v[66:67], v230, s[32:35], s81 offen offset:0 sc1
  buffer_store_dwordx2 v[68:69], v230, s[32:35], s82 offen offset:0 sc1
  buffer_store_dwordx2 v[70:71], v230, s[32:35], s83 offen offset:0 sc1
  buffer_store_dwordx2 v[72:73], v230, s[32:35], s80 offen offset:512 sc1
  buffer_store_dwordx2 v[74:75], v230, s[32:35], s81 offen offset:512 sc1
  buffer_store_dwordx2 v[76:77], v230, s[32:35], s82 offen offset:512 sc1
  buffer_store_dwordx2 v[78:79], v230, s[32:35], s83 offen offset:512 sc1
  v_pk_add_f32 v[128:129], v[0:1], v[2:3]
  v_pk_mul_f32 v[130:131], v[0:1], v[0:1]
  v_pk_fma_f32 v[130:131], v[2:3], v[2:3], v[130:131]
  v_pk_add_f32 v[128:129], v[128:129], v[4:5]
  v_pk_fma_f32 v[130:131], v[4:5], v[4:5], v[130:131]
  v_pk_add_f32 v[128:129], v[128:129], v[6:7]
  v_pk_fma_f32 v[130:131], v[6:7], v[6:7], v[130:131]
  v_pk_add_f32 v[128:129], v[128:129], v[8:9]
  v_pk_fma_f32 v[130:131], v[8:9], v[8:9], v[130:131]
  v_pk_add_f32 v[128:129], v[128:129], v[10:11]
  v_pk_fma_f32 v[130:131], v[10:11], v[10:11], v[130:131]
  v_pk_add_f32 v[128:129], v[128:129], v[12:13]
  v_pk_fma_f32 v[130:131], v[12:13], v[12:13], v[130:131]
  v_pk_add_f32 v[128:129], v[128:129], v[14:15]
  v_pk_fma_f32 v[130:131], v[14:15], v[14:15], v[130:131]
  v_pk_add_f32 v[132:133], v[16:17], v[18:19]
  v_pk_mul_f32 v[134:135], v[16:17], v[16:17]
  v_pk_fma_f32 v[134:135], v[18:19], v[18:19], v[134:135]
  v_pk_add_f32 v[132:133], v[132:133], v[20:21]
  v_pk_fma_f32 v[134:135], v[20:21], v[20:21], v[134:135]
  v_pk_add_f32 v[132:133], v[132:133], v[22:23]
  v_pk_fma_f32 v[134:135], v[22:23], v[22:23], v[134:135]
  v_pk_add_f32 v[132:133], v[132:133], v[24:25]
  v_pk_fma_f32 v[134:135], v[24:25], v[24:25], v[134:135]
  v_pk_add_f32 v[132:133], v[132:133], v[26:27]
  v_pk_fma_f32 v[134:135], v[26:27], v[26:27], v[134:135]
  v_pk_add_f32 v[132:133], v[132:133], v[28:29]
  v_pk_fma_f32 v[134:135], v[28:29], v[28:29], v[134:135]
  v_pk_add_f32 v[132:133], v[132:133], v[30:31]
  v_pk_fma_f32 v[134:135], v[30:31], v[30:31], v[134:135]
  v_add_f32 v128, v128, v129
  v_add_f32 v129, v130, v131
  v_add_f32 v132, v132, v133
  v_add_f32 v133, v134, v135
  v_mov_b32 v130, v128
  v_mov_b32 v131, v129
  v_mov_b32 v134, v132
  v_mov_b32 v135, v133
  s_nop 1
  v_permlane16_swap_b32 v128, v130
  v_permlane16_swap_b32 v129, v131
  v_permlane16_swap_b32 v132, v134
  v_permlane16_swap_b32 v133, v135
  s_nop 1
  v_add_f32 v128, v128, v130
  v_add_f32 v129, v129, v131
  v_add_f32 v132, v132, v134
  v_add_f32 v133, v133, v135
  v_mov_b32 v130, v128
  v_mov_b32 v131, v129
  v_mov_b32 v134, v132
  v_mov_b32 v135, v133
  s_nop 1
  v_permlane32_swap_b32 v128, v130
  v_permlane32_swap_b32 v129, v131
  v_permlane32_swap_b32 v132, v134
  v_permlane32_swap_b32 v133, v135
  s_nop 1
  v_add_f32 v128, v128, v130
  v_add_f32 v129, v129, v131
  v_add_f32 v132, v132, v134
  v_add_f32 v133, v133, v135
  s_mov_b64 exec, 0xffff
  buffer_store_dwordx2 v[128:129], v231, s[40:43], 0 offen sc1
  buffer_store_dwordx2 v[132:133], v231, s[40:43], 0 offen offset:128 sc1
  s_mov_b64 exec, -1
  s_waitcnt vmcnt(0)
  s_branch L_resdone_46
L_final_45:
  s_mul_i32 s59, s74, 262144
  s_lshl_b32 s60, s75, 7
  s_add_u32 s59, s59, s60
  s_sub_u32 s60, 4194304, s59
  s_add_u32 s32, s16, s59
  s_addc_u32 s33, s17, 0
  s_mov_b32 s34, s60
  s_mov_b32 s35, 0x00020000
  v_and_b32 v240, 15, v255
  v_add_u32 v240, s61, v240
  v_lshlrev_b32 v240, 11, v240
  v_bfe_u32 v241, v255, 4, 1
  v_lshlrev_b32 v241, 1, v241
  v_lshrrev_b32 v242, 5, v255
  v_or_b32 v241, v241, v242
  v_lshl_add_u32 v240, v241, 4, v240
  s_mov_b32 s52, 32768
  v_permlane16_swap_b32 v64, v66
  v_permlane16_swap_b32 v65, v67
  v_permlane16_swap_b32 v68, v70
  v_permlane16_swap_b32 v69, v71
  v_permlane16_swap_b32 v72, v74
  v_permlane16_swap_b32 v73, v75
  v_permlane16_swap_b32 v76, v78
  v_permlane16_swap_b32 v77, v79
  buffer_store_dwordx4 v[64:67], v240, s[32:35], 0 offen offset:0 sc1
  buffer_store_dwordx4 v[68:71], v240, s[32:35], 0 offen offset:64 sc1
  buffer_store_dwordx4 v[72:75], v240, s[32:35], s52 offen offset:0 sc1
  buffer_store_dwordx4 v[76:79], v240, s[32:35], s52 offen offset:64 sc1
L_resdone_46:
  s_barrier
  s_add_u32 s71, s71, 1
  s_cmp_lt_u32 s71, 2
  s_cbranch_scc1 L_clayer_4
  s_endpgm
L_loader:
  s_setprio 0
  s_sub_u32 s89, s48, 4
  v_and_b32 v1, 63, v0
  v_mov_b32 v10, 152576
  v_mov_b32 v11, 0
  ds_write_b32 v10, v11
  s_mul_i32 s60, s72, 262144
  s_cmp_lg_u32 s71, 0
  s_cbranch_scc1 L_la1_47
  s_add_u32 s24, s4, s60
  s_addc_u32 s25, s5, 0
  s_mov_b32 s26, 262144
  s_mov_b32 s27, 0x00020000
  v_lshrrev_b32 v10, 3, v1
  v_and_b32 v11, 7, v1
  v_lshrrev_b32 v12, 4, v1
  v_lshlrev_b32 v13, 11, v10
  v_or_b32 v14, 0, v12
  v_xor_b32 v14, v14, v11
  v_lshl_add_u32 v2, v14, 4, v13
  v_or_b32 v14, 4, v12
  v_xor_b32 v14, v14, v11
  v_lshl_add_u32 v3, v14, 4, v13
  v_add_u32 v3, 15360, v3
  v_or_b32 v14, 0, v12
  v_xor_b32 v14, v14, v11
  v_lshl_add_u32 v4, v14, 4, v13
  v_add_u32 v4, 30720, v4
  v_or_b32 v14, 4, v12
  v_xor_b32 v14, v14, v11
  v_lshl_add_u32 v5, v14, 4, v13
  v_add_u32 v5, 46080, v5
  s_lshl_b32 s69, s89, 12
  s_mov_b32 s64, 128
  s_lshl_b32 s87, s89, 16
  s_branch L_laj_48
L_la1_47:
  s_add_u32 s24, s20, 8388608
  s_addc_u32 s25, s21, 0
  s_add_u32 s24, s24, s60
  s_addc_u32 s25, s25, 0
  s_mov_b32 s26, 262144
  s_mov_b32 s27, 0x00020000
  v_lshlrev_b32 v2, 4, v1
  v_mov_b32 v3, v2
  v_mov_b32 v4, v2
  v_mov_b32 v5, v2
  s_lshl_b32 s69, s89, 12
  s_mov_b32 s87, s69
  s_mov_b32 s64, 16384
L_laj_48:
  s_lshl_b32 s60, s73, 7
  s_sub_u32 s63, 6291456, s60
  s_add_u32 s28, s6, s60
  s_addc_u32 s29, s7, 0
  s_mov_b32 s30, s63
  s_mov_b32 s31, 0x00020000
  v_lshrrev_b32 v10, 3, v1
  v_and_b32 v11, 7, v1
  v_bfe_u32 v12, v1, 4, 1
  s_lshl_b32 s52, s89, 4
  v_add_u32 v13, s52, v10
  s_mov_b32 s59, 6144
  v_mul_lo_u32 v13, v13, s59
  v_lshlrev_b32 v14, 1, v12
  v_xor_b32 v14, v14, v11
  v_lshl_add_u32 v6, v14, 4, v13
  v_or_b32 v14, 2, v12
  v_lshlrev_b32 v14, 1, v14
  v_xor_b32 v14, v14, v11
  v_lshl_add_u32 v7, v14, 4, v13
  v_add_u32 v7, 48128, v7
  s_lshl_b32 s70, s89, 11
  s_add_u32 s70, s70, 16384
  s_mov_b32 s65, 16
  s_cmp_lg_u32 s71, 0
  s_cbranch_scc1 L_r1_49
  s_mul_i32 s63, s72, 1
  s_mul_i32 s52, s73, 1
  s_add_u32 s63, s63, s52
  s_and_b32 s63, s63, 15
  s_branch L_rd_50
L_r1_49:
  s_mul_i32 s63, s72, 0
  s_mul_i32 s52, s73, 0
  s_add_u32 s63, s63, s52
  s_and_b32 s63, s63, 15
L_rd_50:
  s_mul_i32 s54, s63, s64
  s_mul_i32 s68, s65, s64
  s_mul_i32 s55, s63, 393216
  s_mul_i32 s88, s65, 393216
  s_add_u32 m0, s70, 0
  s_add_u32 s52, s55, 0
  buffer_load_dwordx4 v6, s[28:31], s52 offen offset:0  lds
  buffer_load_dwordx4 v7, s[28:31], s52 offen offset:1024  lds
  s_add_u32 m0, s70, 8192
  s_add_u32 s52, s55, 2048
  buffer_load_dwordx4 v6, s[28:31], s52 offen offset:0  lds
  buffer_load_dwordx4 v7, s[28:31], s52 offen offset:1024  lds
  s_add_u32 m0, s70, 16384
  s_add_u32 s52, s55, 4096
  buffer_load_dwordx4 v6, s[28:31], s52 offen offset:0  lds
  buffer_load_dwordx4 v7, s[28:31], s52 offen offset:1024  lds
  s_add_u32 s55, s55, 393216
  s_cmp_eq_u32 s55, s88
  s_cselect_b32 s55, 0, s55
  s_add_u32 m0, s70, 40960
  s_add_u32 s52, s55, 0
  buffer_load_dwordx4 v6, s[28:31], s52 offen offset:0  lds
  buffer_load_dwordx4 v7, s[28:31], s52 offen offset:1024  lds
  s_add_u32 m0, s70, 49152
  s_add_u32 s52, s55, 2048
  buffer_load_dwordx4 v6, s[28:31], s52 offen offset:0  lds
  buffer_load_dwordx4 v7, s[28:31], s52 offen offset:1024  lds
  s_add_u32 m0, s70, 57344
  s_add_u32 s52, s55, 4096
  buffer_load_dwordx4 v6, s[28:31], s52 offen offset:0  lds
  buffer_load_dwordx4 v7, s[28:31], s52 offen offset:1024  lds
  s_add_u32 s55, s55, 393216
  s_cmp_eq_u32 s55, s88
  s_cselect_b32 s55, 0, s55
  s_add_u32 m0, s69, 0
  s_add_u32 s52, s54, s87
  buffer_load_dwordx4 v2, s[24:27], s52 offen offset:0 sc1 lds
  buffer_load_dwordx4 v3, s[24:27], s52 offen offset:1024 sc1 lds
  buffer_load_dwordx4 v4, s[24:27], s52 offen offset:2048 sc1 lds
  buffer_load_dwordx4 v5, s[24:27], s52 offen offset:3072 sc1 lds
  s_add_u32 s54, s54, s64
  s_cmp_eq_u32 s54, s68
  s_cselect_b32 s54, 0, s54
  s_add_u32 m0, s69, 40960
  s_add_u32 s52, s54, s87
  buffer_load_dwordx4 v2, s[24:27], s52 offen offset:0 sc1 lds
  buffer_load_dwordx4 v3, s[24:27], s52 offen offset:1024 sc1 lds
  buffer_load_dwordx4 v4, s[24:27], s52 offen offset:2048 sc1 lds
  buffer_load_dwordx4 v5, s[24:27], s52 offen offset:3072 sc1 lds
  s_add_u32 s54, s54, s64
  s_cmp_eq_u32 s54, s68
  s_cselect_b32 s54, 0, s54
  s_waitcnt vmcnt(4)
  s_barrier
  s_add_u32 s80, s72, s73
  s_and_b32 s80, s80, 15
  v_lshrrev_b32 v8, 4, v1
  v_bfe_u32 v9, v1, 2, 2
  v_lshl_add_u32 v14, v8, 3, v9
  v_lshlrev_b32 v14, 7, v14
  v_and_b32 v10, 3, v1
  v_lshl_add_u32 v14, v10, 3, v14
  v_add_u32 v14, 16384, v14
  v_and_b32 v8, 1, v8
  v_lshlrev_b32 v8, 1, v8
  v_lshrrev_b32 v9, 1, v9
  v_or_b32 v15, v8, v9
  v_mov_b32 v116, 0x3f803f80
  v_mov_b32 v117, 0x3f803f80
  v_mov_b32 v118, 0x3f803f80
  v_mov_b32 v119, 0x3f803f80
  s_mul_i32 s52, s89, 3
  s_add_u32 s52, s52, 0
  s_and_b32 s59, s52, 3
  s_lshr_b32 s52, s52, 2
  s_lshl_b32 s52, s52, 13
  v_xor_b32 v8, s59, v15
  v_lshl_add_u32 v8, v8, 5, v14
  v_add_u32 v8, s52, v8
  ds_read_b64_tr_b16 v[68:69], v8 offset:0
  ds_read_b64_tr_b16 v[70:71], v8 offset:512
  ds_read_b64_tr_b16 v[72:73], v8 offset:4096
  ds_read_b64_tr_b16 v[74:75], v8 offset:4608
  s_mul_i32 s52, s89, 3
  s_add_u32 s52, s52, 1
  s_and_b32 s59, s52, 3
  s_lshr_b32 s52, s52, 2
  s_lshl_b32 s52, s52, 13
  v_xor_b32 v8, s59, v15
  v_lshl_add_u32 v8, v8, 5, v14
  v_add_u32 v8, s52, v8
  ds_read_b64_tr_b16 v[76:77], v8 offset:0
  ds_read_b64_tr_b16 v[78:79], v8 offset:512
  ds_read_b64_tr_b16 v[80:81], v8 offset:4096
  ds_read_b64_tr_b16 v[82:83], v8 offset:4608
  s_mul_i32 s52, s89, 3
  s_add_u32 s52, s52, 2
  s_and_b32 s59, s52, 3
  s_lshr_b32 s52, s52, 2
  s_lshl_b32 s52, s52, 13
  v_xor_b32 v8, s59, v15
  v_lshl_add_u32 v8, v8, 5, v14
  v_add_u32 v8, s52, v8
  ds_read_b64_tr_b16 v[84:85], v8 offset:0
  ds_read_b64_tr_b16 v[86:87], v8 offset:512
  ds_read_b64_tr_b16 v[88:89], v8 offset:4096
  ds_read_b64_tr_b16 v[90:91], v8 offset:4608
  s_waitcnt lgkmcnt(0)
  v_mfma_f32_16x16x32_bf16 v[100:103], v[116:119], v[68:71], 0
  v_mfma_f32_16x16x32_bf16 v[100:103], v[116:119], v[72:75], v[100:103]
  v_mfma_f32_16x16x32_bf16 v[104:107], v[116:119], v[76:79], 0
  v_mfma_f32_16x16x32_bf16 v[104:107], v[116:119], v[80:83], v[104:107]
  v_mfma_f32_16x16x32_bf16 v[108:111], v[116:119], v[84:87], 0
  v_mfma_f32_16x16x32_bf16 v[108:111], v[116:119], v[88:91], v[108:111]
  s_add_u32 m0, s69, 81920
  s_add_u32 s52, s54, s87
  buffer_load_dwordx4 v2, s[24:27], s52 offen offset:0 sc1 lds
  buffer_load_dwordx4 v3, s[24:27], s52 offen offset:1024 sc1 lds
  buffer_load_dwordx4 v4, s[24:27], s52 offen offset:2048 sc1 lds
  buffer_load_dwordx4 v5, s[24:27], s52 offen offset:3072 sc1 lds
  s_add_u32 s54, s54, s64
  s_cmp_eq_u32 s54, s68
  s_cselect_b32 s54, 0, s54
  s_add_u32 m0, s70, 81920
  s_add_u32 s52, s55, 0
  buffer_load_dwordx4 v6, s[28:31], s52 offen offset:0  lds
  buffer_load_dwordx4 v7, s[28:31], s52 offen offset:1024  lds
  s_add_u32 m0, s70, 90112
  s_add_u32 s52, s55, 2048
  buffer_load_dwordx4 v6, s[28:31], s52 offen offset:0  lds
  buffer_load_dwordx4 v7, s[28:31], s52 offen offset:1024  lds
  s_add_u32 m0, s70, 98304
  s_add_u32 s52, s55, 4096
  buffer_load_dwordx4 v6, s[28:31], s52 offen offset:0  lds
  buffer_load_dwordx4 v7, s[28:31], s52 offen offset:1024  lds
  s_add_u32 s55, s55, 393216
  s_cmp_eq_u32 s55, s88
  s_cselect_b32 s55, 0, s55
  s_lshl_b32 s59, s73, 14
  s_lshl_b32 s60, s80, 10
  s_add_u32 s59, s59, s60
  s_add_u32 s44, s20, 34603008
  s_addc_u32 s45, s21, 0
  s_add_u32 s44, s44, s59
  s_addc_u32 s45, s45, 0
  s_mov_b32 s46, 1024
  s_mov_b32 s47, 0x00020000
  v_and_b32 v8, 15, v1
  v_lshlrev_b32 v8, 2, v8
  s_mul_i32 s52, s89, 192
  v_add_u32 v8, s52, v8
  s_mov_b64 exec, 0xffff
  s_nop 2
  buffer_store_dword v100, v8, s[44:47], 0 offen offset:0 sc1
  buffer_store_dword v104, v8, s[44:47], 0 offen offset:64 sc1
  buffer_store_dword v108, v8, s[44:47], 0 offen offset:128 sc1
  s_mov_b64 exec, -1
  v_lshrrev_b32 v8, 3, v1
  s_lshl_b32 s52, s89, 5
  v_add_u32 v8, s52, v8
  v_lshlrev_b32 v8, 11, v8
  v_and_b32 v9, 7, v1
  v_lshl_add_u32 v8, v9, 4, v8
  s_lshl_b32 s52, s73, 7
  v_add_u32 v8, s52, v8
  s_mov_b32 s52, 0
  buffer_load_dwordx4 v[52:55], v8, s[24:27], s52 offen
  s_mov_b32 s52, 16384
  buffer_load_dwordx4 v[56:59], v8, s[24:27], s52 offen
  s_mov_b32 s52, 32768
  buffer_load_dwordx4 v[60:63], v8, s[24:27], s52 offen
  s_mov_b32 s52, 49152
  buffer_load_dwordx4 v[64:67], v8, s[24:27], s52 offen
  s_mov_b32 s40, s18
  s_mov_b32 s41, s19
  s_mov_b32 s42, 256
  s_mov_b32 s43, 0x00020000
  v_and_b32 v8, 3, v1
  v_lshlrev_b32 v8, 6, v8
  buffer_load_dword v120, v8, s[40:43], 0 offen sc1
  s_waitcnt vmcnt(18)
  s_barrier
  s_add_u32 m0, s69, 0
  s_add_u32 s52, s54, s87
  buffer_load_dwordx4 v2, s[24:27], s52 offen offset:0 sc1 lds
  buffer_load_dwordx4 v3, s[24:27], s52 offen offset:1024 sc1 lds
  buffer_load_dwordx4 v4, s[24:27], s52 offen offset:2048 sc1 lds
  buffer_load_dwordx4 v5, s[24:27], s52 offen offset:3072 sc1 lds
  s_add_u32 s54, s54, s64
  s_cmp_eq_u32 s54, s68
  s_cselect_b32 s54, 0, s54
  s_add_u32 m0, s70, 0
  s_add_u32 s52, s55, 0
  buffer_load_dwordx4 v6, s[28:31], s52 offen offset:0  lds
  buffer_load_dwordx4 v7, s[28:31], s52 offen offset:1024  lds
  s_add_u32 m0, s70, 8192
  s_add_u32 s52, s55, 2048
  buffer_load_dwordx4 v6, s[28:31], s52 offen offset:0  lds
  buffer_load_dwordx4 v7, s[28:31], s52 offen offset:1024  lds
  s_add_u32 m0, s70, 16384
  s_add_u32 s52, s55, 4096
  buffer_load_dwordx4 v6, s[28:31], s52 offen offset:0  lds
  buffer_load_dwordx4 v7, s[28:31], s52 offen offset:1024  lds
  s_add_u32 s55, s55, 393216
  s_cmp_eq_u32 s55, s88
  s_cselect_b32 s55, 0, s55
  s_waitcnt vmcnt(18)
  s_barrier
  s_add_u32 m0, s69, 40960
  s_add_u32 s52, s54, s87
  buffer_load_dwordx4 v2, s[24:27], s52 offen offset:0 sc1 lds
  buffer_load_dwordx4 v3, s[24:27], s52 offen offset:1024 sc1 lds
  buffer_load_dwordx4 v4, s[24:27], s52 offen offset:2048 sc1 lds
  buffer_load_dwordx4 v5, s[24:27], s52 offen offset:3072 sc1 lds
  s_add_u32 s54, s54, s64
  s_cmp_eq_u32 s54, s68
  s_cselect_b32 s54, 0, s54
  s_add_u32 m0, s70, 40960
  s_add_u32 s52, s55, 0
  buffer_load_dwordx4 v6, s[28:31], s52 offen offset:0  lds
  buffer_load_dwordx4 v7, s[28:31], s52 offen offset:1024  lds
  s_add_u32 m0, s70, 49152
  s_add_u32 s52, s55, 2048
  buffer_load_dwordx4 v6, s[28:31], s52 offen offset:0  lds
  buffer_load_dwordx4 v7, s[28:31], s52 offen offset:1024  lds
  s_add_u32 m0, s70, 57344
  s_add_u32 s52, s55, 4096
  buffer_load_dwordx4 v6, s[28:31], s52 offen offset:0  lds
  buffer_load_dwordx4 v7, s[28:31], s52 offen offset:1024  lds
  s_add_u32 s55, s55, 393216
  s_cmp_eq_u32 s55, s88
  s_cselect_b32 s55, 0, s55
  s_waitcnt vmcnt(21)
  v_mov_b32 v20, 0
  v_mov_b32 v21, 0
  v_mov_b32 v22, 0
  v_mov_b32 v23, 0
  v_lshlrev_b32 v24, 16, v52
  v_and_b32 v25, 0xffff0000, v52
  v_pk_add_f32 v[20:21], v[20:21], v[24:25]
  v_pk_fma_f32 v[22:23], v[24:25], v[24:25], v[22:23]
  v_lshlrev_b32 v24, 16, v53
  v_and_b32 v25, 0xffff0000, v53
  v_pk_add_f32 v[20:21], v[20:21], v[24:25]
  v_pk_fma_f32 v[22:23], v[24:25], v[24:25], v[22:23]
  v_lshlrev_b32 v24, 16, v54
  v_and_b32 v25, 0xffff0000, v54
  v_pk_add_f32 v[20:21], v[20:21], v[24:25]
  v_pk_fma_f32 v[22:23], v[24:25], v[24:25], v[22:23]
  v_lshlrev_b32 v24, 16, v55
  v_and_b32 v25, 0xffff0000, v55
  v_pk_add_f32 v[20:21], v[20:21], v[24:25]
  v_pk_fma_f32 v[22:23], v[24:25], v[24:25], v[22:23]
  v_add_f32 v26, v20, v21
  v_add_f32 v27, v22, v23
  v_mov_b32 v20, 0
  v_mov_b32 v21, 0
  v_mov_b32 v22, 0
  v_mov_b32 v23, 0
  v_lshlrev_b32 v24, 16, v56
  v_and_b32 v25, 0xffff0000, v56
  v_pk_add_f32 v[20:21], v[20:21], v[24:25]
  v_pk_fma_f32 v[22:23], v[24:25], v[24:25], v[22:23]
  v_lshlrev_b32 v24, 16, v57
  v_and_b32 v25, 0xffff0000, v57
  v_pk_add_f32 v[20:21], v[20:21], v[24:25]
  v_pk_fma_f32 v[22:23], v[24:25], v[24:25], v[22:23]
  v_lshlrev_b32 v24, 16, v58
  v_and_b32 v25, 0xffff0000, v58
  v_pk_add_f32 v[20:21], v[20:21], v[24:25]
  v_pk_fma_f32 v[22:23], v[24:25], v[24:25], v[22:23]
  v_lshlrev_b32 v24, 16, v59
  v_and_b32 v25, 0xffff0000, v59
  v_pk_add_f32 v[20:21], v[20:21], v[24:25]
  v_pk_fma_f32 v[22:23], v[24:25], v[24:25], v[22:23]
  v_add_f32 v28, v20, v21
  v_add_f32 v29, v22, v23
  v_mov_b32 v20, 0
  v_mov_b32 v21, 0
  v_mov_b32 v22, 0
  v_mov_b32 v23, 0
  v_lshlrev_b32 v24, 16, v60
  v_and_b32 v25, 0xffff0000, v60
  v_pk_add_f32 v[20:21], v[20:21], v[24:25]
  v_pk_fma_f32 v[22:23], v[24:25], v[24:25], v[22:23]
  v_lshlrev_b32 v24, 16, v61
  v_and_b32 v25, 0xffff0000, v61
  v_pk_add_f32 v[20:21], v[20:21], v[24:25]
  v_pk_fma_f32 v[22:23], v[24:25], v[24:25], v[22:23]
  v_lshlrev_b32 v24, 16, v62
  v_and_b32 v25, 0xffff0000, v62
  v_pk_add_f32 v[20:21], v[20:21], v[24:25]
  v_pk_fma_f32 v[22:23], v[24:25], v[24:25], v[22:23]
  v_lshlrev_b32 v24, 16, v63
  v_and_b32 v25, 0xffff0000, v63
  v_pk_add_f32 v[20:21], v[20:21], v[24:25]
  v_pk_fma_f32 v[22:23], v[24:25], v[24:25], v[22:23]
  v_add_f32 v30, v20, v21
  v_add_f32 v31, v22, v23
  v_mov_b32 v20, 0
  v_mov_b32 v21, 0
  v_mov_b32 v22, 0
  v_mov_b32 v23, 0
  v_lshlrev_b32 v24, 16, v64
  v_and_b32 v25, 0xffff0000, v64
  v_pk_add_f32 v[20:21], v[20:21], v[24:25]
  v_pk_fma_f32 v[22:23], v[24:25], v[24:25], v[22:23]
  v_lshlrev_b32 v24, 16, v65
  v_and_b32 v25, 0xffff0000, v65
  v_pk_add_f32 v[20:21], v[20:21], v[24:25]
  v_pk_fma_f32 v[22:23], v[24:25], v[24:25], v[22:23]
  v_lshlrev_b32 v24, 16, v66
  v_and_b32 v25, 0xffff0000, v66
  v_pk_add_f32 v[20:21], v[20:21], v[24:25]
  v_pk_fma_f32 v[22:23], v[24:25], v[24:25], v[22:23]
  v_lshlrev_b32 v24, 16, v67
  v_and_b32 v25, 0xffff0000, v67
  v_pk_add_f32 v[20:21], v[20:21], v[24:25]
  v_pk_fma_f32 v[22:23], v[24:25], v[24:25], v[22:23]
  v_add_f32 v32, v20, v21
  v_add_f32 v33, v22, v23
  s_nop 1
  v_add_f32_dpp v26, v26, v26 quad_perm:[1,0,3,2] row_mask:0xf bank_mask:0xf
  v_add_f32_dpp v27, v27, v27 quad_perm:[1,0,3,2] row_mask:0xf bank_mask:0xf
  v_add_f32_dpp v28, v28, v28 quad_perm:[1,0,3,2] row_mask:0xf bank_mask:0xf
  v_add_f32_dpp v29, v29, v29 quad_perm:[1,0,3,2] row_mask:0xf bank_mask:0xf
  v_add_f32_dpp v30, v30, v30 quad_perm:[1,0,3,2] row_mask:0xf bank_mask:0xf
  v_add_f32_dpp v31, v31, v31 quad_perm:[1,0,3,2] row_mask:0xf bank_mask:0xf
  v_add_f32_dpp v32, v32, v32 quad_perm:[1,0,3,2] row_mask:0xf bank_mask:0xf
  v_add_f32_dpp v33, v33, v33 quad_perm:[1,0,3,2] row_mask:0xf bank_mask:0xf
  s_nop 1
  v_add_f32_dpp v26, v26, v26 quad_perm:[2,3,0,1] row_mask:0xf bank_mask:0xf
  v_add_f32_dpp v27, v27, v27 quad_perm:[2,3,0,1] row_mask:0xf bank_mask:0xf
  v_add_f32_dpp v28, v28, v28 quad_perm:[2,3,0,1] row_mask:0xf bank_mask:0xf
  v_add_f32_dpp v29, v29, v29 quad_perm:[2,3,0,1] row_mask:0xf bank_mask:0xf
  v_add_f32_dpp v30, v30, v30 quad_perm:[2,3,0,1] row_mask:0xf bank_mask:0xf
  v_add_f32_dpp v31, v31, v31 quad_perm:[2,3,0,1] row_mask:0xf bank_mask:0xf
  v_add_f32_dpp v32, v32, v32 quad_perm:[2,3,0,1] row_mask:0xf bank_mask:0xf
  v_add_f32_dpp v33, v33, v33 quad_perm:[2,3,0,1] row_mask:0xf bank_mask:0xf
  s_nop 1
  v_add_f32_dpp v26, v26, v26 row_half_mirror row_mask:0xf bank_mask:0xf
  v_add_f32_dpp v27, v27, v27 row_half_mirror row_mask:0xf bank_mask:0xf
  v_add_f32_dpp v28, v28, v28 row_half_mirror row_mask:0xf bank_mask:0xf
  v_add_f32_dpp v29, v29, v29 row_half_mirror row_mask:0xf bank_mask:0xf
  v_add_f32_dpp v30, v30, v30 row_half_mirror row_mask:0xf bank_mask:0xf
  v_add_f32_dpp v31, v31, v31 row_half_mirror row_mask:0xf bank_mask:0xf
  v_add_f32_dpp v32, v32, v32 row_half_mirror row_mask:0xf bank_mask:0xf
  v_add_f32_dpp v33, v33, v33 row_half_mirror row_mask:0xf bank_mask:0xf
  s_nop 1
  s_lshl_b32 s59, s73, 14
  s_lshl_b32 s60, s72, 10
  s_add_u32 s59, s59, s60
  s_mov_b32 s60, 33554432
  s_add_u32 s59, s59, s60
  s_add_u32 s44, s20, s59
  s_addc_u32 s45, s21, 0
  s_mov_b32 s46, 1024
  s_mov_b32 s47, 0x00020000
  v_lshrrev_b32 v8, 3, v1
  v_lshlrev_b32 v8, 3, v8
  s_lshl_b32 s52, s89, 8
  v_add_u32 v8, s52, v8
  s_mov_b32 exec_lo, 0x01010101
  s_mov_b32 exec_hi, 0x01010101
  buffer_store_dwordx2 v[26:27], v8, s[44:47], 0 offen offset:0 sc1
  buffer_store_dwordx2 v[28:29], v8, s[44:47], 0 offen offset:64 sc1
  buffer_store_dwordx2 v[30:31], v8, s[44:47], 0 offen offset:128 sc1
  buffer_store_dwordx2 v[32:33], v8, s[44:47], 0 offen offset:192 sc1
  s_mov_b64 exec, -1
  s_waitcnt vmcnt(14)
  s_barrier
  s_add_u32 m0, s69, 81920
  s_add_u32 s52, s54, s87
  buffer_load_dwordx4 v2, s[24:27], s52 offen offset:0 sc1 lds
  buffer_load_dwordx4 v3, s[24:27], s52 offen offset:1024 sc1 lds
  buffer_load_dwordx4 v4, s[24:27], s52 offen offset:2048 sc1 lds
  buffer_load_dwordx4 v5, s[24:27], s52 offen offset:3072 sc1 lds
  s_add_u32 s54, s54, s64
  s_cmp_eq_u32 s54, s68
  s_cselect_b32 s54, 0, s54
  s_add_u32 m0, s70, 81920
  s_add_u32 s52, s55, 0
  buffer_load_dwordx4 v6, s[28:31], s52 offen offset:0  lds
  buffer_load_dwordx4 v7, s[28:31], s52 offen offset:1024  lds
  s_add_u32 m0, s70, 90112
  s_add_u32 s52, s55, 2048
  buffer_load_dwordx4 v6, s[28:31], s52 offen offset:0  lds
  buffer_load_dwordx4 v7, s[28:31], s52 offen offset:1024  lds
  s_add_u32 m0, s70, 98304
  s_add_u32 s52, s55, 4096
  buffer_load_dwordx4 v6, s[28:31], s52 offen offset:0  lds
  buffer_load_dwordx4 v7, s[28:31], s52 offen offset:1024  lds
  s_add_u32 s55, s55, 393216
  s_cmp_eq_u32 s55, s88
  s_cselect_b32 s55, 0, s55
  v_and_b32 v8, 3, v1
  v_lshlrev_b32 v8, 6, v8
  s_mov_b32 s94, 0x20000
L_ilp_52:
  v_cmp_gt_u32 vcc, 64, v120
  s_nop 4
  s_and_b32 s52, vcc_lo, 0xf
  s_cmp_eq_u32 s52, 0
  s_cbranch_scc1 L_iok_51
  s_sub_u32 s94, s94, 1
  s_cmp_eq_u32 s94, 0
  s_cbranch_scc1 L_iok_51
  s_sleep 1
  buffer_load_dword v120, v8, s[40:43], 0 offen sc1
  s_waitcnt vmcnt(0)
  s_branch L_ilp_52
L_iok_51:
  s_waitcnt vmcnt(14)
  s_barrier
  s_add_u32 m0, s69, 0
  s_add_u32 s52, s54, s87
  buffer_load_dwordx4 v2, s[24:27], s52 offen offset:0 sc1 lds
  buffer_load_dwordx4 v3, s[24:27], s52 offen offset:1024 sc1 lds
  buffer_load_dwordx4 v4, s[24:27], s52 offen offset:2048 sc1 lds
  buffer_load_dwordx4 v5, s[24:27], s52 offen offset:3072 sc1 lds
  s_add_u32 s54, s54, s64
  s_cmp_eq_u32 s54, s68
  s_cselect_b32 s54, 0, s54
  s_add_u32 m0, s70, 0
  s_add_u32 s52, s55, 0
  buffer_load_dwordx4 v6, s[28:31], s52 offen offset:0  lds
  buffer_load_dwordx4 v7, s[28:31], s52 offen offset:1024  lds
  s_add_u32 m0, s70, 8192
  s_add_u32 s52, s55, 2048
  buffer_load_dwordx4 v6, s[28:31], s52 offen offset:0  lds
  buffer_load_dwordx4 v7, s[28:31], s52 offen offset:1024  lds
  s_add_u32 m0, s70, 16384
  s_add_u32 s52, s55, 4096
  buffer_load_dwordx4 v6, s[28:31], s52 offen offset:0  lds
  buffer_load_dwordx4 v7, s[28:31], s52 offen offset:1024  lds
  s_add_u32 s55, s55, 393216
  s_cmp_eq_u32 s55, s88
  s_cselect_b32 s55, 0, s55
  s_waitcnt vmcnt(20)
  s_add_u32 s60, s73, 160
  s_lshl_b32 s60, s60, 7
  v_mov_b32 v8, 0
  v_mov_b32 v9, 1
  s_mov_b64 exec, 1
  buffer_atomic_add v9, v8, s[76:79], s60 offen sc1
  s_mov_b64 exec, -1
  s_add_u32 s60, s72, 144
  s_lshl_b32 s60, s60, 7
  v_mov_b32 v8, 0
  v_mov_b32 v9, 1
  s_mov_b64 exec, 1
  buffer_atomic_add v9, v8, s[76:79], s60 offen sc1
  s_mov_b64 exec, -1
  s_waitcnt vmcnt(12)
  s_barrier
  s_add_u32 m0, s69, 40960
  s_add_u32 s52, s54, s87
  buffer_load_dwordx4 v2, s[24:27], s52 offen offset:0 sc1 lds
  buffer_load_dwordx4 v3, s[24:27], s52 offen offset:1024 sc1 lds
  buffer_load_dwordx4 v4, s[24:27], s52 offen offset:2048 sc1 lds
  buffer_load_dwordx4 v5, s[24:27], s52 offen offset:3072 sc1 lds
  s_add_u32 s54, s54, s64
  s_cmp_eq_u32 s54, s68
  s_cselect_b32 s54, 0, s54
  s_add_u32 m0, s70, 40960
  s_add_u32 s52, s55, 0
  buffer_load_dwordx4 v6, s[28:31], s52 offen offset:0  lds
  buffer_load_dwordx4 v7, s[28:31], s52 offen offset:1024  lds
  s_add_u32 m0, s70, 49152
  s_add_u32 s52, s55, 2048
  buffer_load_dwordx4 v6, s[28:31], s52 offen offset:0  lds
  buffer_load_dwordx4 v7, s[28:31], s52 offen offset:1024  lds
  s_add_u32 m0, s70, 57344
  s_add_u32 s52, s55, 4096
  buffer_load_dwordx4 v6, s[28:31], s52 offen offset:0  lds
  buffer_load_dwordx4 v7, s[28:31], s52 offen offset:1024  lds
  s_add_u32 s55, s55, 393216
  s_cmp_eq_u32 s55, s88
  s_cselect_b32 s55, 0, s55
  s_waitcnt vmcnt(12)
  s_barrier
  s_add_u32 m0, s69, 81920
  s_add_u32 s52, s54, s87
  buffer_load_dwordx4 v2, s[24:27], s52 offen offset:0 sc1 lds
  buffer_load_dwordx4 v3, s[24:27], s52 offen offset:1024 sc1 lds
  buffer_load_dwordx4 v4, s[24:27], s52 offen offset:2048 sc1 lds
  buffer_load_dwordx4 v5, s[24:27], s52 offen offset:3072 sc1 lds
  s_add_u32 s54, s54, s64
  s_cmp_eq_u32 s54, s68
  s_cselect_b32 s54, 0, s54
  s_add_u32 m0, s70, 81920
  s_add_u32 s52, s55, 0
  buffer_load_dwordx4 v6, s[28:31], s52 offen offset:0  lds
  buffer_load_dwordx4 v7, s[28:31], s52 offen offset:1024  lds
  s_add_u32 m0, s70, 90112
  s_add_u32 s52, s55, 2048
  buffer_load_dwordx4 v6, s[28:31], s52 offen offset:0  lds
  buffer_load_dwordx4 v7, s[28:31], s52 offen offset:1024  lds
  s_add_u32 m0, s70, 98304
  s_add_u32 s52, s55, 4096
  buffer_load_dwordx4 v6, s[28:31], s52 offen offset:0  lds
  buffer_load_dwordx4 v7, s[28:31], s52 offen offset:1024  lds
  s_add_u32 s55, s55, 393216
  s_cmp_eq_u32 s55, s88
  s_cselect_b32 s55, 0, s55
  s_waitcnt vmcnt(10)
  s_barrier
  s_add_u32 m0, s69, 0
  s_add_u32 s52, s54, s87
  buffer_load_dwordx4 v2, s[24:27], s52 offen offset:0 sc1 lds
  buffer_load_dwordx4 v3, s[24:27], s52 offen offset:1024 sc1 lds
  buffer_load_dwordx4 v4, s[24:27], s52 offen offset:2048 sc1 lds
  buffer_load_dwordx4 v5, s[24:27], s52 offen offset:3072 sc1 lds
  s_add_u32 s54, s54, s64
  s_cmp_eq_u32 s54, s68
  s_cselect_b32 s54, 0, s54
  s_add_u32 m0, s70, 0
  s_add_u32 s52, s55, 0
  buffer_load_dwordx4 v6, s[28:31], s52 offen offset:0  lds
  buffer_load_dwordx4 v7, s[28:31], s52 offen offset:1024  lds
  s_add_u32 m0, s70, 8192
  s_add_u32 s52, s55, 2048
  buffer_load_dwordx4 v6, s[28:31], s52 offen offset:0  lds
  buffer_load_dwordx4 v7, s[28:31], s52 offen offset:1024  lds
  s_add_u32 m0, s70, 16384
  s_add_u32 s52, s55, 4096
  buffer_load_dwordx4 v6, s[28:31], s52 offen offset:0  lds
  buffer_load_dwordx4 v7, s[28:31], s52 offen offset:1024  lds
  s_add_u32 s55, s55, 393216
  s_cmp_eq_u32 s55, s88
  s_cselect_b32 s55, 0, s55
  s_add_u32 s60, s73, 160
  s_lshl_b32 s60, s60, 7
  v_mov_b32 v8, 0
  buffer_load_dword v121, v8, s[76:79], s60 offen sc1
  s_add_u32 s60, s72, 144
  s_lshl_b32 s60, s60, 7
  buffer_load_dword v122, v8, s[76:79], s60 offen sc1
  s_waitcnt vmcnt(12)
  s_barrier
  s_add_u32 m0, s69, 40960
  s_add_u32 s52, s54, s87
  buffer_load_dwordx4 v2, s[24:27], s52 offen offset:0 sc1 lds
  buffer_load_dwordx4 v3, s[24:27], s52 offen offset:1024 sc1 lds
  buffer_load_dwordx4 v4, s[24:27], s52 offen offset:2048 sc1 lds
  buffer_load_dwordx4 v5, s[24:27], s52 offen offset:3072 sc1 lds
  s_add_u32 s54, s54, s64
  s_cmp_eq_u32 s54, s68
  s_cselect_b32 s54, 0, s54
  s_add_u32 m0, s70, 40960
  s_add_u32 s52, s55, 0
  buffer_load_dwordx4 v6, s[28:31], s52 offen offset:0  lds
  buffer_load_dwordx4 v7, s[28:31], s52 offen offset:1024  lds
  s_add_u32 m0, s70, 49152
  s_add_u32 s52, s55, 2048
  buffer_load_dwordx4 v6, s[28:31], s52 offen offset:0  lds
  buffer_load_dwordx4 v7, s[28:31], s52 offen offset:1024  lds
  s_add_u32 m0, s70, 57344
  s_add_u32 s52, s55, 4096
  buffer_load_dwordx4 v6, s[28:31], s52 offen offset:0  lds
  buffer_load_dwordx4 v7, s[28:31], s52 offen offset:1024  lds
  s_add_u32 s55, s55, 393216
  s_cmp_eq_u32 s55, s88
  s_cselect_b32 s55, 0, s55
  s_waitcnt vmcnt(12)
  s_barrier
  s_add_u32 m0, s69, 81920
  s_add_u32 s52, s54, s87
  buffer_load_dwordx4 v2, s[24:27], s52 offen offset:0 sc1 lds
  buffer_load_dwordx4 v3, s[24:27], s52 offen offset:1024 sc1 lds
  buffer_load_dwordx4 v4, s[24:27], s52 offen offset:2048 sc1 lds
  buffer_load_dwordx4 v5, s[24:27], s52 offen offset:3072 sc1 lds
  s_add_u32 s54, s54, s64
  s_cmp_eq_u32 s54, s68
  s_cselect_b32 s54, 0, s54
  s_add_u32 m0, s70, 81920
  s_add_u32 s52, s55, 0
  buffer_load_dwordx4 v6, s[28:31], s52 offen offset:0  lds
  buffer_load_dwordx4 v7, s[28:31], s52 offen offset:1024  lds
  s_add_u32 m0, s70, 90112
  s_add_u32 s52, s55, 2048
  buffer_load_dwordx4 v6, s[28:31], s52 offen offset:0  lds
  buffer_load_dwordx4 v7, s[28:31], s52 offen offset:1024  lds
  s_add_u32 m0, s70, 98304
  s_add_u32 s52, s55, 4096
  buffer_load_dwordx4 v6, s[28:31], s52 offen offset:0  lds
  buffer_load_dwordx4 v7, s[28:31], s52 offen offset:1024  lds
  s_add_u32 s55, s55, 393216
  s_cmp_eq_u32 s55, s88
  s_cselect_b32 s55, 0, s55
  s_waitcnt vmcnt(21)
  s_waitcnt vmcnt(20)
  s_mov_b32 s63, 64
  v_readfirstlane_b32 s52, v121
  s_nop 3
  s_cmp_ge_u32 s52, s63
  s_cbranch_scc1 L_pk_53
  s_add_u32 s60, s73, 160
  s_lshl_b32 s60, s60, 7
  v_mov_b32 v8, 0
  s_mov_b32 s94, 0x20000
L_poll_54:
  buffer_load_dword v9, v8, s[76:79], s60 offen sc1
  s_waitcnt vmcnt(0)
  v_readfirstlane_b32 s52, v9
  s_nop 3
  s_cmp_ge_u32 s52, s63
  s_cbranch_scc1 L_pok_55
  s_sub_u32 s94, s94, 1
  s_cmp_eq_u32 s94, 0
  s_cbranch_scc1 L_pok_55
  s_sleep 1
  s_branch L_poll_54
L_pok_55:
L_pk_53:
  v_readfirstlane_b32 s52, v122
  s_nop 3
  s_cmp_ge_u32 s52, s63
  s_cbranch_scc1 L_pk_56
  s_add_u32 s60, s72, 144
  s_lshl_b32 s60, s60, 7
  v_mov_b32 v8, 0
  s_mov_b32 s94, 0x20000
L_poll_57:
  buffer_load_dword v9, v8, s[76:79], s60 offen sc1
  s_waitcnt vmcnt(0)
  v_readfirstlane_b32 s52, v9
  s_nop 3
  s_cmp_ge_u32 s52, s63
  s_cbranch_scc1 L_pok_58
  s_sub_u32 s94, s94, 1
  s_cmp_eq_u32 s94, 0
  s_cbranch_scc1 L_pok_58
  s_sleep 1
  s_branch L_poll_57
L_pok_58:
L_pk_56:
  s_mov_b32 s60, 33554432
  s_lshl_b32 s59, s72, 10
  s_add_u32 s60, s60, s59
  s_add_u32 s40, s20, s60
  s_addc_u32 s41, s21, 0
  s_mov_b32 s42, 262144
  s_mov_b32 s43, 0x00020000
  v_subrev_u32 v13, 256, v0
  v_and_b32 v8, 127, v13
  v_lshrrev_b32 v9, 7, v13
  v_lshlrev_b32 v8, 3, v8
  v_lshl_add_u32 v8, v9, 17, v8
  s_mov_b32 s52, 0
  buffer_load_dwordx2 v[20:21], v8, s[40:43], s52 offen sc1
  s_mov_b32 s52, 16384
  buffer_load_dwordx2 v[22:23], v8, s[40:43], s52 offen sc1
  s_mov_b32 s52, 32768
  buffer_load_dwordx2 v[24:25], v8, s[40:43], s52 offen sc1
  s_mov_b32 s52, 49152
  buffer_load_dwordx2 v[26:27], v8, s[40:43], s52 offen sc1
  s_mov_b32 s52, 65536
  buffer_load_dwordx2 v[28:29], v8, s[40:43], s52 offen sc1
  s_mov_b32 s52, 81920
  buffer_load_dwordx2 v[30:31], v8, s[40:43], s52 offen sc1
  s_mov_b32 s52, 98304
  buffer_load_dwordx2 v[32:33], v8, s[40:43], s52 offen sc1
  s_mov_b32 s52, 114688
  buffer_load_dwordx2 v[34:35], v8, s[40:43], s52 offen sc1
  s_lshl_b32 s59, s73, 14
  s_add_u32 s44, s20, 34603008
  s_addc_u32 s45, s21, 0
  s_add_u32 s44, s44, s59
  s_addc_u32 s45, s45, 0
  s_mov_b32 s46, 16384
  s_mov_b32 s47, 0x00020000
  v_lshlrev_b32 v9, 2, v13
  buffer_load_dword v36, v9, s[44:47], 0 offen offset:0 sc1
  buffer_load_dword v37, v9, s[44:47], 0 offen offset:1024 sc1
  buffer_load_dword v38, v9, s[44:47], 0 offen offset:2048 sc1
  buffer_load_dword v39, v9, s[44:47], 0 offen offset:3072 sc1
  s_mov_b32 s52, 4096
  buffer_load_dword v40, v9, s[44:47], s52 offen offset:0 sc1
  s_mov_b32 s52, 4096
  buffer_load_dword v41, v9, s[44:47], s52 offen offset:1024 sc1
  s_mov_b32 s52, 4096
  buffer_load_dword v42, v9, s[44:47], s52 offen offset:2048 sc1
  s_mov_b32 s52, 4096
  buffer_load_dword v43, v9, s[44:47], s52 offen offset:3072 sc1
  s_mov_b32 s52, 8192
  buffer_load_dword v44, v9, s[44:47], s52 offen offset:0 sc1
  s_mov_b32 s52, 8192
  buffer_load_dword v45, v9, s[44:47], s52 offen offset:1024 sc1
  s_mov_b32 s52, 8192
  buffer_load_dword v46, v9, s[44:47], s52 offen offset:2048 sc1
  s_mov_b32 s52, 8192
  buffer_load_dword v47, v9, s[44:47], s52 offen offset:3072 sc1
  s_mov_b32 s52, 12288
  buffer_load_dword v48, v9, s[44:47], s52 offen offset:0 sc1
  s_mov_b32 s52, 12288
  buffer_load_dword v49, v9, s[44:47], s52 offen offset:1024 sc1
  s_mov_b32 s52, 12288
  buffer_load_dword v50, v9, s[44:47], s52 offen offset:2048 sc1
  s_mov_b32 s52, 12288
  buffer_load_dword v51, v9, s[44:47], s52 offen offset:3072 sc1
  s_waitcnt vmcnt(34)
  s_barrier
  s_add_u32 m0, s69, 0
  s_add_u32 s52, s54, s87
  buffer_load_dwordx4 v2, s[24:27], s52 offen offset:0 sc1 lds
  buffer_load_dwordx4 v3, s[24:27], s52 offen offset:1024 sc1 lds
  buffer_load_dwordx4 v4, s[24:27], s52 offen offset:2048 sc1 lds
  buffer_load_dwordx4 v5, s[24:27], s52 offen offset:3072 sc1 lds
  s_add_u32 s54, s54, s64
  s_cmp_eq_u32 s54, s68
  s_cselect_b32 s54, 0, s54
  s_add_u32 m0, s70, 0
  s_add_u32 s52, s55, 0
  buffer_load_dwordx4 v6, s[28:31], s52 offen offset:0  lds
  buffer_load_dwordx4 v7, s[28:31], s52 offen offset:1024  lds
  s_add_u32 m0, s70, 8192
  s_add_u32 s52, s55, 2048
  buffer_load_dwordx4 v6, s[28:31], s52 offen offset:0  lds
  buffer_load_dwordx4 v7, s[28:31], s52 offen offset:1024  lds
  s_add_u32 m0, s70, 16384
  s_add_u32 s52, s55, 4096
  buffer_load_dwordx4 v6, s[28:31], s52 offen offset:0  lds
  buffer_load_dwordx4 v7, s[28:31], s52 offen offset:1024  lds
  s_add_u32 s55, s55, 393216
  s_cmp_eq_u32 s55, s88
  s_cselect_b32 s55, 0, s55
  s_waitcnt vmcnt(34)
  s_barrier
  s_add_u32 m0, s69, 40960
  s_add_u32 s52, s54, s87
  buffer_load_dwordx4 v2, s[24:27], s52 offen offset:0 sc1 lds
  buffer_load_dwordx4 v3, s[24:27], s52 offen offset:1024 sc1 lds
  buffer_load_dwordx4 v4, s[24:27], s52 offen offset:2048 sc1 lds
  buffer_load_dwordx4 v5, s[24:27], s52 offen offset:3072 sc1 lds
  s_add_u32 s54, s54, s64
  s_cmp_eq_u32 s54, s68
  s_cselect_b32 s54, 0, s54
  s_add_u32 m0, s70, 40960
  s_add_u32 s52, s55, 0
  buffer_load_dwordx4 v6, s[28:31], s52 offen offset:0  lds
  buffer_load_dwordx4 v7, s[28:31], s52 offen offset:1024  lds
  s_add_u32 m0, s70, 49152
  s_add_u32 s52, s55, 2048
  buffer_load_dwordx4 v6, s[28:31], s52 offen offset:0  lds
  buffer_load_dwordx4 v7, s[28:31], s52 offen offset:1024  lds
  s_add_u32 m0, s70, 57344
  s_add_u32 s52, s55, 4096
  buffer_load_dwordx4 v6, s[28:31], s52 offen offset:0  lds
  buffer_load_dwordx4 v7, s[28:31], s52 offen offset:1024  lds
  s_add_u32 s55, s55, 393216
  s_cmp_eq_u32 s55, s88
  s_cselect_b32 s55, 0, s55
  s_waitcnt vmcnt(20)
  v_add_f32 v20, v20, v22
  v_add_f32 v21, v21, v23
  v_add_f32 v20, v20, v24
  v_add_f32 v21, v21, v25
  v_add_f32 v20, v20, v26
  v_add_f32 v21, v21, v27
  v_add_f32 v20, v20, v28
  v_add_f32 v21, v21, v29
  v_add_f32 v20, v20, v30
  v_add_f32 v21, v21, v31
  v_add_f32 v20, v20, v32
  v_add_f32 v21, v21, v33
  v_add_f32 v20, v20, v34
  v_add_f32 v21, v21, v35
  v_add_f32 v36, v36, v37
  v_add_f32 v36, v36, v38
  v_add_f32 v36, v36, v39
  v_add_f32 v36, v36, v40
  v_add_f32 v36, v36, v41
  v_add_f32 v36, v36, v42
  v_add_f32 v36, v36, v43
  v_add_f32 v36, v36, v44
  v_add_f32 v36, v36, v45
  v_add_f32 v36, v36, v46
  v_add_f32 v36, v36, v47
  v_add_f32 v36, v36, v48
  v_add_f32 v36, v36, v49
  v_add_f32 v36, v36, v50
  v_add_f32 v36, v36, v51
  v_lshlrev_b32 v8, 3, v13
  v_add_u32 v8, 149504, v8
  ds_write_b64 v8, v[20:21]
  v_lshlrev_b32 v8, 2, v13
  v_add_u32 v8, 148480, v8
  ds_write_b32 v8, v36
  s_waitcnt lgkmcnt(0)
  s_waitcnt vmcnt(10)
  s_barrier
  s_add_u32 m0, s69, 81920
  s_add_u32 s52, s54, s87
  buffer_load_dwordx4 v2, s[24:27], s52 offen offset:0 sc1 lds
  buffer_load_dwordx4 v3, s[24:27], s52 offen offset:1024 sc1 lds
  buffer_load_dwordx4 v4, s[24:27], s52 offen offset:2048 sc1 lds
  buffer_load_dwordx4 v5, s[24:27], s52 offen offset:3072 sc1 lds
  s_add_u32 s54, s54, s64
  s_cmp_eq_u32 s54, s68
  s_cselect_b32 s54, 0, s54
  s_add_u32 m0, s70, 81920
  s_add_u32 s52, s55, 0
  buffer_load_dwordx4 v6, s[28:31], s52 offen offset:0  lds
  buffer_load_dwordx4 v7, s[28:31], s52 offen offset:1024  lds
  s_add_u32 m0, s70, 90112
  s_add_u32 s52, s55, 2048
  buffer_load_dwordx4 v6, s[28:31], s52 offen offset:0  lds
  buffer_load_dwordx4 v7, s[28:31], s52 offen offset:1024  lds
  s_add_u32 m0, s70, 98304
  s_add_u32 s52, s55, 4096
  buffer_load_dwordx4 v6, s[28:31], s52 offen offset:0  lds
  buffer_load_dwordx4 v7, s[28:31], s52 offen offset:1024  lds
  s_add_u32 s55, s55, 393216
  s_cmp_eq_u32 s55, s88
  s_cselect_b32 s55, 0, s55
  s_cmp_ge_u32 s48, 6
  s_cbranch_scc1 L_sb_59
  v_lshlrev_b32 v8, 3, v13
  v_add_u32 v8, 149504, v8
  ds_read_b64 v[20:21], v8
  ds_read_b64 v[22:23], v8 offset:1024
  s_waitcnt lgkmcnt(0)
  v_add_f32 v20, v20, v22
  v_add_f32 v21, v21, v23
  v_mul_f32 v20, 0x3a800000, v20
  v_mul_f32 v21, 0x3a800000, v21
  v_fma_f32 v21, -v20, v20, v21
  v_max_f32 v21, 0, v21
  v_add_f32 v21, 0x3727c5ac, v21
  v_rsq_f32 v21, v21
  v_sub_f32 v20, 0, v20
  v_lshlrev_b32 v8, 2, v13
  v_add_u32 v8, 147456, v8
  ds_write_b32 v8, v20
  ds_write_b32 v8, v21 offset:512
  s_waitcnt lgkmcnt(0)
L_sb_59:
  s_waitcnt vmcnt(10)
  s_barrier
  s_add_u32 m0, s69, 0
  s_add_u32 s52, s54, s87
  buffer_load_dwordx4 v2, s[24:27], s52 offen offset:0 sc1 lds
  buffer_load_dwordx4 v3, s[24:27], s52 offen offset:1024 sc1 lds
  buffer_load_dwordx4 v4, s[24:27], s52 offen offset:2048 sc1 lds
  buffer_load_dwordx4 v5, s[24:27], s52 offen offset:3072 sc1 lds
  s_add_u32 s54, s54, s64
  s_cmp_eq_u32 s54, s68
  s_cselect_b32 s54, 0, s54
  s_add_u32 m0, s70, 0
  s_add_u32 s52, s55, 0
  buffer_load_dwordx4 v6, s[28:31], s52 offen offset:0  lds
  buffer_load_dwordx4 v7, s[28:31], s52 offen offset:1024  lds
  s_add_u32 m0, s70, 8192
  s_add_u32 s52, s55, 2048
  buffer_load_dwordx4 v6, s[28:31], s52 offen offset:0  lds
  buffer_load_dwordx4 v7, s[28:31], s52 offen offset:1024  lds
  s_add_u32 m0, s70, 16384
  s_add_u32 s52, s55, 4096
  buffer_load_dwordx4 v6, s[28:31], s52 offen offset:0  lds
  buffer_load_dwordx4 v7, s[28:31], s52 offen offset:1024  lds
  s_add_u32 s55, s55, 393216
  s_cmp_eq_u32 s55, s88
  s_cselect_b32 s55, 0, s55
  s_waitcnt vmcnt(10)
  s_barrier
  s_waitcnt vmcnt(0)
  s_barrier
  s_barrier
  s_waitcnt vmcnt(0)
  s_mul_i32 s60, s73, 224
  s_and_b32 s61, s73, 1
  s_lshl_b32 s61, s61, 5
  s_sub_u32 s60, s60, s61
  s_lshl_b32 s61, s60, 1
  s_sub_u32 s63, 7340032, s61
  s_add_u32 s28, s12, s61
  s_addc_u32 s29, s13, 0
  s_mov_b32 s30, s63
  s_mov_b32 s31, 0x00020000
  v_lshrrev_b32 v10, 3, v1
  v_and_b32 v11, 7, v1
  v_bfe_u32 v12, v1, 4, 1
  s_lshl_b32 s52, s89, 4
  v_add_u32 v13, s52, v10
  s_mov_b32 s59, 7168
  v_mul_lo_u32 v13, v13, s59
  v_lshlrev_b32 v14, 1, v12
  v_xor_b32 v14, v14, v11
  v_lshl_add_u32 v6, v14, 4, v13
  v_or_b32 v14, 2, v12
  v_lshlrev_b32 v14, 1, v14
  v_xor_b32 v14, v14, v11
  v_lshl_add_u32 v7, v14, 4, v13
  v_add_u32 v7, 56320, v7
  s_lshl_b32 s70, s89, 11
  s_add_u32 s70, s70, 16384
  s_add_u32 s80, s72, s73
  s_and_b32 s80, s80, 15
  s_mul_i32 s55, s80, 458752
  s_mov_b32 s88, -1
  s_add_u32 m0, s70, 0
  s_add_u32 s52, s55, 0
  buffer_load_dwordx4 v6, s[28:31], s52 offen offset:0  lds
  buffer_load_dwordx4 v7, s[28:31], s52 offen offset:1024  lds
  s_add_u32 m0, s70, 8192
  s_add_u32 s52, s55, 128
  buffer_load_dwordx4 v6, s[28:31], s52 offen offset:0  lds
  buffer_load_dwordx4 v7, s[28:31], s52 offen offset:1024  lds
  s_add_u32 m0, s70, 16384
  s_add_u32 s52, s55, 256
  buffer_load_dwordx4 v6, s[28:31], s52 offen offset:0  lds
  buffer_load_dwordx4 v7, s[28:31], s52 offen offset:1024  lds
  s_add_u32 m0, s70, 24576
  s_add_u32 s52, s55, 384
  buffer_load_dwordx4 v6, s[28:31], s52 offen offset:0  lds
  buffer_load_dwordx4 v7, s[28:31], s52 offen offset:1024  lds
  s_add_u32 s55, s55, 458752
  s_cmp_eq_u32 s55, s88
  s_cselect_b32 s55, 0, s55
  s_branch L_atail_60
L_llayer_61:
  s_cmp_lg_u32 s48, 4
  s_cbranch_scc1 L_oth_62
  s_add_u32 s60, s72, 128
  s_lshl_b32 s60, s60, 7
  v_mov_b32 v120, 0
  s_mov_b32 s94, 0x20000
L_poll_64:
  buffer_load_dword v121, v120, s[76:79], s60 offen sc1
  s_waitcnt vmcnt(0)
  v_readfirstlane_b32 s52, v121
  s_nop 3
  s_cmp_ge_u32 s52, 16
  s_cbranch_scc1 L_pok_65
  s_sub_u32 s94, s94, 1
  s_cmp_eq_u32 s94, 0
  s_cbranch_scc1 L_pok_65
  s_sleep 1
  s_branch L_poll_64
L_pok_65:
  s_lshl_b32 s52, s71, 2
  s_add_u32 s52, s52, 0
  v_mov_b32 v10, 152576
  v_mov_b32 v11, s52
  ds_write_b32 v10, v11
  s_waitcnt lgkmcnt(0)
  s_branch L_wdn_63
L_oth_62:
  s_lshl_b32 s63, s71, 2
  s_add_u32 s63, s63, 0
  v_mov_b32 v10, 152576
  s_mov_b32 s94, 0x1000000
L_fw_66:
  ds_read_b32 v11, v10
  s_waitcnt lgkmcnt(0)
  v_readfirstlane_b32 s52, v11
  s_nop 3
  s_cmp_ge_u32 s52, s63
  s_cbranch_scc1 L_fok_67
  s_sub_u32 s94, s94, 1
  s_cmp_eq_u32 s94, 0
  s_cbranch_scc1 L_fok_67
  s_sleep 1
  s_branch L_fw_66
L_fok_67:
L_wdn_63:
  s_add_u32 m0, s69, 0
  s_add_u32 s52, s54, s87
  buffer_load_dwordx4 v2, s[24:27], s52 offen offset:0 sc1 lds
  buffer_load_dwordx4 v3, s[24:27], s52 offen offset:1024 sc1 lds
  buffer_load_dwordx4 v4, s[24:27], s52 offen offset:2048 sc1 lds
  buffer_load_dwordx4 v5, s[24:27], s52 offen offset:3072 sc1 lds
  s_add_u32 s54, s54, s64
  s_cmp_eq_u32 s54, s68
  s_cselect_b32 s54, 0, s54
  s_add_u32 m0, s69, 40960
  s_add_u32 s52, s54, s87
  buffer_load_dwordx4 v2, s[24:27], s52 offen offset:0 sc1 lds
  buffer_load_dwordx4 v3, s[24:27], s52 offen offset:1024 sc1 lds
  buffer_load_dwordx4 v4, s[24:27], s52 offen offset:2048 sc1 lds
  buffer_load_dwordx4 v5, s[24:27], s52 offen offset:3072 sc1 lds
  s_add_u32 s54, s54, s64
  s_cmp_eq_u32 s54, s68
  s_cselect_b32 s54, 0, s54
  s_waitcnt vmcnt(4)
  s_barrier
  s_add_u32 m0, s69, 81920
  s_add_u32 s52, s54, s87
  buffer_load_dwordx4 v2, s[24:27], s52 offen offset:0 sc1 lds
  buffer_load_dwordx4 v3, s[24:27], s52 offen offset:1024 sc1 lds
  buffer_load_dwordx4 v4, s[24:27], s52 offen offset:2048 sc1 lds
  buffer_load_dwordx4 v5, s[24:27], s52 offen offset:3072 sc1 lds
  s_add_u32 s54, s54, s64
  s_cmp_eq_u32 s54, s68
  s_cselect_b32 s54, 0, s54
  s_add_u32 m0, s70, 81920
  s_add_u32 s52, s55, 0
  buffer_load_dwordx4 v6, s[28:31], s52 offen offset:0  lds
  buffer_load_dwordx4 v7, s[28:31], s52 offen offset:1024  lds
  s_add_u32 m0, s70, 90112
  s_add_u32 s52, s55, 2048
  buffer_load_dwordx4 v6, s[28:31], s52 offen offset:0  lds
  buffer_load_dwordx4 v7, s[28:31], s52 offen offset:1024  lds
  s_add_u32 m0, s70, 98304
  s_add_u32 s52, s55, 4096
  buffer_load_dwordx4 v6, s[28:31], s52 offen offset:0  lds
  buffer_load_dwordx4 v7, s[28:31], s52 offen offset:1024  lds
  s_add_u32 s55, s55, 393216
  s_cmp_eq_u32 s55, s88
  s_cselect_b32 s55, 0, s55
  s_waitcnt vmcnt(10)
  s_barrier
  s_add_u32 m0, s69, 0
  s_add_u32 s52, s54, s87
  buffer_load_dwordx4 v2, s[24:27], s52 offen offset:0 sc1 lds
  buffer_load_dwordx4 v3, s[24:27], s52 offen offset:1024 sc1 lds
  buffer_load_dwordx4 v4, s[24:27], s52 offen offset:2048 sc1 lds
  buffer_load_dwordx4 v5, s[24:27], s52 offen offset:3072 sc1 lds
  s_add_u32 s54, s54, s64
  s_cmp_eq_u32 s54, s68
  s_cselect_b32 s54, 0, s54
  s_add_u32 m0, s70, 0
  s_add_u32 s52, s55, 0
  buffer_load_dwordx4 v6, s[28:31], s52 offen offset:0  lds
  buffer_load_dwordx4 v7, s[28:31], s52 offen offset:1024  lds
  s_add_u32 m0, s70, 8192
  s_add_u32 s52, s55, 2048
  buffer_load_dwordx4 v6, s[28:31], s52 offen offset:0  lds
  buffer_load_dwordx4 v7, s[28:31], s52 offen offset:1024  lds
  s_add_u32 m0, s70, 16384
  s_add_u32 s52, s55, 4096
  buffer_load_dwordx4 v6, s[28:31], s52 offen offset:0  lds
  buffer_load_dwordx4 v7, s[28:31], s52 offen offset:1024  lds
  s_add_u32 s55, s55, 393216
  s_cmp_eq_u32 s55, s88
  s_cselect_b32 s55, 0, s55
  s_waitcnt vmcnt(10)
  s_barrier
  s_sub_u32 s53, s65, 4
  s_mov_b32 s51, 40960
L_ld_68:
  s_add_u32 m0, s69, s51
  s_add_u32 s52, s54, s87
  buffer_load_dwordx4 v2, s[24:27], s52 offen offset:0 sc1 lds
  buffer_load_dwordx4 v3, s[24:27], s52 offen offset:1024 sc1 lds
  buffer_load_dwordx4 v4, s[24:27], s52 offen offset:2048 sc1 lds
  buffer_load_dwordx4 v5, s[24:27], s52 offen offset:3072 sc1 lds
  s_add_u32 s54, s54, s64
  s_cmp_eq_u32 s54, s68
  s_cselect_b32 s54, 0, s54
  s_add_u32 s59, s70, s51
  s_mov_b32 m0, s59
  s_add_u32 s52, s55, 0
  buffer_load_dwordx4 v6, s[28:31], s52 offen offset:0  lds
  buffer_load_dwordx4 v7, s[28:31], s52 offen offset:1024  lds
  s_add_u32 m0, s59, 8192
  s_add_u32 s52, s55, 2048
  buffer_load_dwordx4 v6, s[28:31], s52 offen offset:0  lds
  buffer_load_dwordx4 v7, s[28:31], s52 offen offset:1024  lds
  s_add_u32 m0, s59, 16384
  s_add_u32 s52, s55, 4096
  buffer_load_dwordx4 v6, s[28:31], s52 offen offset:0  lds
  buffer_load_dwordx4 v7, s[28:31], s52 offen offset:1024  lds
  s_add_u32 s55, s55, 393216
  s_cmp_eq_u32 s55, s88
  s_cselect_b32 s55, 0, s55
  s_add_u32 s51, s51, 40960
  s_cmp_eq_u32 s51, 122880
  s_cselect_b32 s51, 0, s51
  s_waitcnt vmcnt(10)
  s_barrier
  s_sub_u32 s53, s53, 1
  s_cmp_lg_u32 s53, 0
  s_cbranch_scc1 L_ld_68
  s_waitcnt vmcnt(0)
  s_barrier
  s_waitcnt vmcnt(0)
  s_barrier
L_atail_60:
  s_mul_i32 s59, s71, 3145728
  s_add_u32 s59, s59, 27262976
  s_lshr_b32 s52, s48, 1
  s_lshl_b32 s52, s52, 7
  s_lshl_b32 s60, s73, 1
  s_add_u32 s52, s52, s60
  s_and_b32 s60, s48, 1
  s_add_u32 s52, s52, s60
  s_mul_i32 s52, s52, 2112
  s_add_u32 s59, s59, s52
  s_add_u32 s36, s20, s59
  s_addc_u32 s37, s21, 0
  s_mov_b32 s38, 204864
  s_mov_b32 s39, 0x00020000
  v_lshlrev_b32 v16, 4, v1
  v_lshrrev_b32 v17, 4, v1
  v_lshlrev_b32 v17, 4, v17
  v_add_u32 v17, 2048, v17
  s_barrier
  s_waitcnt vmcnt(0)
  s_barrier
  buffer_load_dwordx4 v[64:67], v16, s[36:39], 0 offen offset:0 sc1
  buffer_load_dwordx4 v[68:71], v16, s[36:39], 0 offen offset:1024 sc1
  buffer_load_dwordx4 v[72:75], v17, s[36:39], 0 offen sc1
  s_mov_b32 s52, 67584
  buffer_load_dwordx4 v[76:79], v16, s[36:39], s52 offen offset:0 sc1
  buffer_load_dwordx4 v[80:83], v16, s[36:39], s52 offen offset:1024 sc1
  buffer_load_dwordx4 v[84:87], v17, s[36:39], s52 offen sc1
  s_mov_b32 s52, 135168
  buffer_load_dwordx4 v[88:91], v16, s[36:39], s52 offen offset:0 sc1
  buffer_load_dwordx4 v[92:95], v16, s[36:39], s52 offen offset:1024 sc1
  buffer_load_dwordx4 v[96:99], v17, s[36:39], s52 offen sc1
  s_mov_b32 s52, 202752
  buffer_load_dwordx4 v[100:103], v16, s[36:39], s52 offen offset:0 sc1
  buffer_load_dwordx4 v[104:107], v16, s[36:39], s52 offen offset:1024 sc1
  buffer_load_dwordx4 v[108:111], v17, s[36:39], s52 offen sc1
  s_mul_i32 s52, s48, 6144
  s_add_u32 s52, s52, 98304
  v_add_u32 v8, s52, v16
  s_waitcnt vmcnt(9)
  v_lshlrev_b32 v32, 16, v64
  v_and_b32 v33, 0xffff0000, v64
  v_lshlrev_b32 v34, 16, v65
  v_and_b32 v35, 0xffff0000, v65
  v_lshlrev_b32 v36, 16, v66
  v_and_b32 v37, 0xffff0000, v66
  v_lshlrev_b32 v38, 16, v67
  v_and_b32 v39, 0xffff0000, v67
  v_lshlrev_b32 v40, 16, v68
  v_and_b32 v41, 0xffff0000, v68
  v_lshlrev_b32 v42, 16, v69
  v_and_b32 v43, 0xffff0000, v69
  v_lshlrev_b32 v44, 16, v70
  v_and_b32 v45, 0xffff0000, v70
  v_lshlrev_b32 v46, 16, v71
  v_and_b32 v47, 0xffff0000, v71
  v_lshlrev_b32 v48, 16, v72
  v_and_b32 v49, 0xffff0000, v72
  v_lshlrev_b32 v50, 16, v73
  v_and_b32 v51, 0xffff0000, v73
  v_lshlrev_b32 v52, 16, v74
  v_and_b32 v53, 0xffff0000, v74
  v_lshlrev_b32 v54, 16, v75
  v_and_b32 v55, 0xffff0000, v75
  s_waitcnt vmcnt(6)
  v_lshlrev_b32 v112, 16, v76
  v_and_b32 v113, 0xffff0000, v76
  v_lshlrev_b32 v114, 16, v77
  v_and_b32 v115, 0xffff0000, v77
  v_lshlrev_b32 v116, 16, v78
  v_and_b32 v117, 0xffff0000, v78
  v_lshlrev_b32 v118, 16, v79
  v_and_b32 v119, 0xffff0000, v79
  v_pk_add_f32 v[32:33], v[32:33], v[112:113]
  v_pk_add_f32 v[34:35], v[34:35], v[114:115]
  v_pk_add_f32 v[36:37], v[36:37], v[116:117]
  v_pk_add_f32 v[38:39], v[38:39], v[118:119]
  v_lshlrev_b32 v112, 16, v80
  v_and_b32 v113, 0xffff0000, v80
  v_lshlrev_b32 v114, 16, v81
  v_and_b32 v115, 0xffff0000, v81
  v_lshlrev_b32 v116, 16, v82
  v_and_b32 v117, 0xffff0000, v82
  v_lshlrev_b32 v118, 16, v83
  v_and_b32 v119, 0xffff0000, v83
  v_pk_add_f32 v[40:41], v[40:41], v[112:113]
  v_pk_add_f32 v[42:43], v[42:43], v[114:115]
  v_pk_add_f32 v[44:45], v[44:45], v[116:117]
  v_pk_add_f32 v[46:47], v[46:47], v[118:119]
  v_lshlrev_b32 v112, 16, v84
  v_and_b32 v113, 0xffff0000, v84
  v_lshlrev_b32 v114, 16, v85
  v_and_b32 v115, 0xffff0000, v85
  v_lshlrev_b32 v116, 16, v86
  v_and_b32 v117, 0xffff0000, v86
  v_lshlrev_b32 v118, 16, v87
  v_and_b32 v119, 0xffff0000, v87
  v_pk_add_f32 v[48:49], v[48:49], v[112:113]
  v_pk_add_f32 v[50:51], v[50:51], v[114:115]
  v_pk_add_f32 v[52:53], v[52:53], v[116:117]
  v_pk_add_f32 v[54:55], v[54:55], v[118:119]
  s_waitcnt vmcnt(3)
  v_lshlrev_b32 v112, 16, v88
  v_and_b32 v113, 0xffff0000, v88
  v_lshlrev_b32 v114, 16, v89
  v_and_b32 v115, 0xffff0000, v89
  v_lshlrev_b32 v116, 16, v90
  v_and_b32 v117, 0xffff0000, v90
  v_lshlrev_b32 v118, 16, v91
  v_and_b32 v119, 0xffff0000, v91
  v_pk_add_f32 v[32:33], v[32:33], v[112:113]
  v_pk_add_f32 v[34:35], v[34:35], v[114:115]
  v_pk_add_f32 v[36:37], v[36:37], v[116:117]
  v_pk_add_f32 v[38:39], v[38:39], v[118:119]
  v_lshlrev_b32 v112, 16, v92
  v_and_b32 v113, 0xffff0000, v92
  v_lshlrev_b32 v114, 16, v93
  v_and_b32 v115, 0xffff0000, v93
  v_lshlrev_b32 v116, 16, v94
  v_and_b32 v117, 0xffff0000, v94
  v_lshlrev_b32 v118, 16, v95
  v_and_b32 v119, 0xffff0000, v95
  v_pk_add_f32 v[40:41], v[40:41], v[112:113]
  v_pk_add_f32 v[42:43], v[42:43], v[114:115]
  v_pk_add_f32 v[44:45], v[44:45], v[116:117]
  v_pk_add_f32 v[46:47], v[46:47], v[118:119]
  v_lshlrev_b32 v112, 16, v96
  v_and_b32 v113, 0xffff0000, v96
  v_lshlrev_b32 v114, 16, v97
  v_and_b32 v115, 0xffff0000, v97
  v_lshlrev_b32 v116, 16, v98
  v_and_b32 v117, 0xffff0000, v98
  v_lshlrev_b32 v118, 16, v99
  v_and_b32 v119, 0xffff0000, v99
  v_pk_add_f32 v[48:49], v[48:49], v[112:113]
  v_pk_add_f32 v[50:51], v[50:51], v[114:115]
  v_pk_add_f32 v[52:53], v[52:53], v[116:117]
  v_pk_add_f32 v[54:55], v[54:55], v[118:119]
  s_waitcnt vmcnt(0)
  v_lshlrev_b32 v112, 16, v100
  v_and_b32 v113, 0xffff0000, v100
  v_lshlrev_b32 v114, 16, v101
  v_and_b32 v115, 0xffff0000, v101
  v_lshlrev_b32 v116, 16, v102
  v_and_b32 v117, 0xffff0000, v102
  v_lshlrev_b32 v118, 16, v103
  v_and_b32 v119, 0xffff0000, v103
  v_pk_add_f32 v[32:33], v[32:33], v[112:113]
  v_pk_add_f32 v[34:35], v[34:35], v[114:115]
  v_pk_add_f32 v[36:37], v[36:37], v[116:117]
  v_pk_add_f32 v[38:39], v[38:39], v[118:119]
  v_lshlrev_b32 v112, 16, v104
  v_and_b32 v113, 0xffff0000, v104
  v_lshlrev_b32 v114, 16, v105
  v_and_b32 v115, 0xffff0000, v105
  v_lshlrev_b32 v116, 16, v106
  v_and_b32 v117, 0xffff0000, v106
  v_lshlrev_b32 v118, 16, v107
  v_and_b32 v119, 0xffff0000, v107
  v_pk_add_f32 v[40:41], v[40:41], v[112:113]
  v_pk_add_f32 v[42:43], v[42:43], v[114:115]
  v_pk_add_f32 v[44:45], v[44:45], v[116:117]
  v_pk_add_f32 v[46:47], v[46:47], v[118:119]
  v_lshlrev_b32 v112, 16, v108
  v_and_b32 v113, 0xffff0000, v108
  v_lshlrev_b32 v114, 16, v109
  v_and_b32 v115, 0xffff0000, v109
  v_lshlrev_b32 v116, 16, v110
  v_and_b32 v117, 0xffff0000, v110
  v_lshlrev_b32 v118, 16, v111
  v_and_b32 v119, 0xffff0000, v111
  v_pk_add_f32 v[48:49], v[48:49], v[112:113]
  v_pk_add_f32 v[50:51], v[50:51], v[114:115]
  v_pk_add_f32 v[52:53], v[52:53], v[116:117]
  v_pk_add_f32 v[54:55], v[54:55], v[118:119]
  ds_write_b128 v8, v[32:35] offset:0
  ds_write_b128 v8, v[36:39] offset:1024
  ds_write_b128 v8, v[40:43] offset:2048
  ds_write_b128 v8, v[44:47] offset:3072
  ds_write_b128 v8, v[48:51] offset:4096
  ds_write_b128 v8, v[52:55] offset:5120
  s_waitcnt lgkmcnt(0)
  s_barrier
  s_cmp_lg_u32 s71, 0
  s_cbranch_scc1 L_nocsw_69
  v_lshrrev_b32 v8, 4, v1
  v_bfe_u32 v9, v1, 2, 2
  v_lshl_add_u32 v14, v8, 3, v9
  v_lshlrev_b32 v14, 7, v14
  v_and_b32 v10, 3, v1
  v_lshl_add_u32 v14, v10, 3, v14
  v_add_u32 v14, 16384, v14
  v_and_b32 v8, 1, v8
  v_lshlrev_b32 v8, 1, v8
  v_lshrrev_b32 v9, 1, v9
  v_or_b32 v15, v8, v9
  v_mov_b32 v116, 0x3f803f80
  v_mov_b32 v117, 0x3f803f80
  v_mov_b32 v118, 0x3f803f80
  v_mov_b32 v119, 0x3f803f80
  s_lshl_b32 s52, s89, 13
  v_xor_b32 v8, 0, v15
  v_lshl_add_u32 v8, v8, 5, v14
  v_add_u32 v8, s52, v8
  ds_read_b64_tr_b16 v[68:69], v8 offset:0
  ds_read_b64_tr_b16 v[70:71], v8 offset:512
  ds_read_b64_tr_b16 v[72:73], v8 offset:4096
  ds_read_b64_tr_b16 v[74:75], v8 offset:4608
  s_lshl_b32 s52, s89, 13
  v_xor_b32 v8, 1, v15
  v_lshl_add_u32 v8, v8, 5, v14
  v_add_u32 v8, s52, v8
  ds_read_b64_tr_b16 v[76:77], v8 offset:0
  ds_read_b64_tr_b16 v[78:79], v8 offset:512
  ds_read_b64_tr_b16 v[80:81], v8 offset:4096
  ds_read_b64_tr_b16 v[82:83], v8 offset:4608
  s_lshl_b32 s52, s89, 13
  v_xor_b32 v8, 2, v15
  v_lshl_add_u32 v8, v8, 5, v14
  v_add_u32 v8, s52, v8
  ds_read_b64_tr_b16 v[84:85], v8 offset:0
  ds_read_b64_tr_b16 v[86:87], v8 offset:512
  ds_read_b64_tr_b16 v[88:89], v8 offset:4096
  ds_read_b64_tr_b16 v[90:91], v8 offset:4608
  s_lshl_b32 s52, s89, 13
  v_xor_b32 v8, 3, v15
  v_lshl_add_u32 v8, v8, 5, v14
  v_add_u32 v8, s52, v8
  ds_read_b64_tr_b16 v[92:93], v8 offset:0
  ds_read_b64_tr_b16 v[94:95], v8 offset:512
  ds_read_b64_tr_b16 v[96:97], v8 offset:4096
  ds_read_b64_tr_b16 v[98:99], v8 offset:4608
  s_waitcnt lgkmcnt(0)
  v_mfma_f32_16x16x32_bf16 v[100:103], v[116:119], v[68:71], 0
  v_mfma_f32_16x16x32_bf16 v[100:103], v[116:119], v[72:75], v[100:103]
  v_mfma_f32_16x16x32_bf16 v[104:107], v[116:119], v[76:79], 0
  v_mfma_f32_16x16x32_bf16 v[104:107], v[116:119], v[80:83], v[104:107]
  v_mfma_f32_16x16x32_bf16 v[108:111], v[116:119], v[84:87], 0
  v_mfma_f32_16x16x32_bf16 v[108:111], v[116:119], v[88:91], v[108:111]
  v_mfma_f32_16x16x32_bf16 v[112:115], v[116:119], v[92:95], 0
  v_mfma_f32_16x16x32_bf16 v[112:115], v[116:119], v[96:99], v[112:115]
  s_lshl_b32 s59, s73, 14
  s_lshl_b32 s60, s80, 10
  s_add_u32 s59, s59, s60
  s_add_u32 s44, s20, 34865152
  s_addc_u32 s45, s21, 0
  s_add_u32 s44, s44, s59
  s_addc_u32 s45, s45, 0
  s_mov_b32 s46, 1024
  s_mov_b32 s47, 0x00020000
  v_and_b32 v8, 15, v1
  v_lshlrev_b32 v8, 2, v8
  s_lshl_b32 s52, s89, 8
  v_add_u32 v8, s52, v8
  s_mov_b64 exec, 0xffff
  s_nop 7
  buffer_store_dword v100, v8, s[44:47], 0 offen offset:0 sc1
  buffer_store_dword v104, v8, s[44:47], 0 offen offset:64 sc1
  buffer_store_dword v108, v8, s[44:47], 0 offen offset:128 sc1
  buffer_store_dword v112, v8, s[44:47], 0 offen offset:192 sc1
  s_mov_b64 exec, -1
L_nocsw_69:
  s_cmp_lg_u32 s71, 0
  s_cbranch_scc1 L_aux_70
  s_cmp_lg_u32 s48, 4
  s_cbranch_scc1 L_aux_70
  s_add_u32 s60, s75, 208
  s_lshl_b32 s60, s60, 7
  v_mov_b32 v10, 0
  s_mov_b32 s94, 0x20000
L_poll_71:
  buffer_load_dword v11, v10, s[76:79], s60 offen sc1
  s_waitcnt vmcnt(0)
  v_readfirstlane_b32 s52, v11
  s_nop 3
  s_cmp_ge_u32 s52, 64
  s_cbranch_scc1 L_pok_72
  s_sub_u32 s94, s94, 1
  s_cmp_eq_u32 s94, 0
  s_cbranch_scc1 L_pok_72
  s_sleep 1
  s_branch L_poll_71
L_pok_72:
L_aux_70:
  s_barrier
  s_cmp_lg_u32 s48, 4
  s_cbranch_scc1 L_nsig_73
  s_lshl_b32 s60, s71, 4
  s_add_u32 s60, s60, s72
  s_add_u32 s60, s60, 32
  s_lshl_b32 s60, s60, 7
  v_mov_b32 v10, 0
  v_mov_b32 v11, 1
  s_mov_b64 exec, 1
  buffer_atomic_add v11, v10, s[76:79], s60 offen sc1
  s_mov_b64 exec, -1
L_nsig_73:
  s_lshl_b32 s61, s75, 7
  s_mul_i32 s60, s74, 262144
  s_add_u32 s24, s20, s60
  s_addc_u32 s25, s21, 0
  s_mov_b32 s26, 262144
  s_mov_b32 s27, 0x00020000
  s_sub_u32 s63, 2097152, s61
  s_add_u32 s28, s8, s61
  s_addc_u32 s29, s9, 0
  s_mov_b32 s30, s63
  s_mov_b32 s31, 0x00020000
  s_mov_b32 s65, 16
  s_mul_i32 s63, s74, 0
  s_mul_i32 s52, s75, 0
  s_add_u32 s63, s63, s52
  s_and_b32 s63, s63, 15
  v_lshlrev_b32 v2, 4, v1
  v_mov_b32 v3, v2
  v_mov_b32 v4, v2
  v_mov_b32 v5, v2
  s_lshl_b32 s69, s89, 12
  s_mov_b32 s87, s69
  s_mov_b32 s64, 16384
  s_mul_i32 s61, s75, 131072
  s_add_u32 s28, s20, 50331648
  s_addc_u32 s29, s21, 0
  s_add_u32 s28, s28, s61
  s_addc_u32 s29, s29, 0
  s_mov_b32 s30, 131072
  s_mov_b32 s31, 0x00020000
  v_lshlrev_b32 v6, 4, v1
  s_lshl_b32 s52, s89, 11
  v_add_u32 v6, s52, v6
  v_mov_b32 v7, v6
  s_lshl_b32 s70, s89, 11
  s_add_u32 s70, s70, 16384
  s_mul_i32 s54, s63, s64
  s_mul_i32 s68, s65, s64
  s_mul_i32 s55, s63, 8192
  s_mul_i32 s88, s65, 8192
  s_add_u32 m0, s70, 0
  s_add_u32 s52, s55, 0
  buffer_load_dwordx4 v6, s[28:31], s52 offen offset:0 sc1 lds
  buffer_load_dwordx4 v7, s[28:31], s52 offen offset:1024 sc1 lds
  s_add_u32 s55, s55, 8192
  s_cmp_eq_u32 s55, s88
  s_cselect_b32 s55, 0, s55
  s_add_u32 m0, s70, 24576
  s_add_u32 s52, s55, 0
  buffer_load_dwordx4 v6, s[28:31], s52 offen offset:0 sc1 lds
  buffer_load_dwordx4 v7, s[28:31], s52 offen offset:1024 sc1 lds
  s_add_u32 s55, s55, 8192
  s_cmp_eq_u32 s55, s88
  s_cselect_b32 s55, 0, s55
  s_add_u32 m0, s70, 49152
  s_add_u32 s52, s55, 0
  buffer_load_dwordx4 v6, s[28:31], s52 offen offset:0 sc1 lds
  buffer_load_dwordx4 v7, s[28:31], s52 offen offset:1024 sc1 lds
  s_add_u32 s55, s55, 8192
  s_cmp_eq_u32 s55, s88
  s_cselect_b32 s55, 0, s55
  s_cmp_lg_u32 s71, 0
  s_cbranch_scc1 L_nocs2_74
  s_waitcnt vmcnt(6)
  s_add_u32 s60, s73, 176
  s_lshl_b32 s60, s60, 7
  v_mov_b32 v10, 0
  v_mov_b32 v11, 1
  s_mov_b64 exec, 1
  buffer_atomic_add v11, v10, s[76:79], s60 offen sc1
  s_mov_b64 exec, -1
L_nocs2_74:
  s_cmp_lg_u32 s48, 4
  s_cbranch_scc1 L_oth_75
  s_lshl_b32 s60, s71, 4
  s_add_u32 s60, s60, s74
  s_add_u32 s60, s60, 32
  s_lshl_b32 s60, s60, 7
  v_mov_b32 v120, 0
  s_mov_b32 s94, 0x20000
L_poll_77:
  buffer_load_dword v121, v120, s[76:79], s60 offen sc1
  s_waitcnt vmcnt(0)
  v_readfirstlane_b32 s52, v121
  s_nop 3
  s_cmp_ge_u32 s52, 16
  s_cbranch_scc1 L_pok_78
  s_sub_u32 s94, s94, 1
  s_cmp_eq_u32 s94, 0
  s_cbranch_scc1 L_pok_78
  s_sleep 1
  s_branch L_poll_77
L_pok_78:
  s_lshl_b32 s52, s71, 2
  s_add_u32 s52, s52, 1
  v_mov_b32 v10, 152576
  v_mov_b32 v11, s52
  ds_write_b32 v10, v11
  s_waitcnt lgkmcnt(0)
  s_branch L_wdn_76
L_oth_75:
  s_lshl_b32 s63, s71, 2
  s_add_u32 s63, s63, 1
  v_mov_b32 v10, 152576
  s_mov_b32 s94, 0x1000000
L_fw_79:
  ds_read_b32 v11, v10
  s_waitcnt lgkmcnt(0)
  v_readfirstlane_b32 s52, v11
  s_nop 3
  s_cmp_ge_u32 s52, s63
  s_cbranch_scc1 L_fok_80
  s_sub_u32 s94, s94, 1
  s_cmp_eq_u32 s94, 0
  s_cbranch_scc1 L_fok_80
  s_sleep 1
  s_branch L_fw_79
L_fok_80:
L_wdn_76:
  s_waitcnt vmcnt(0)
  s_add_u32 m0, s69, 0
  s_add_u32 s52, s54, s87
  buffer_load_dwordx4 v2, s[24:27], s52 offen offset:0 sc1 lds
  buffer_load_dwordx4 v3, s[24:27], s52 offen offset:1024 sc1 lds
  buffer_load_dwordx4 v4, s[24:27], s52 offen offset:2048 sc1 lds
  buffer_load_dwordx4 v5, s[24:27], s52 offen offset:3072 sc1 lds
  s_add_u32 s54, s54, s64
  s_cmp_eq_u32 s54, s68
  s_cselect_b32 s54, 0, s54
  s_add_u32 m0, s69, 24576
  s_add_u32 s52, s54, s87
  buffer_load_dwordx4 v2, s[24:27], s52 offen offset:0 sc1 lds
  buffer_load_dwordx4 v3, s[24:27], s52 offen offset:1024 sc1 lds
  buffer_load_dwordx4 v4, s[24:27], s52 offen offset:2048 sc1 lds
  buffer_load_dwordx4 v5, s[24:27], s52 offen offset:3072 sc1 lds
  s_add_u32 s54, s54, s64
  s_cmp_eq_u32 s54, s68
  s_cselect_b32 s54, 0, s54
  s_add_u32 m0, s69, 49152
  s_add_u32 s52, s54, s87
  buffer_load_dwordx4 v2, s[24:27], s52 offen offset:0 sc1 lds
  buffer_load_dwordx4 v3, s[24:27], s52 offen offset:1024 sc1 lds
  buffer_load_dwordx4 v4, s[24:27], s52 offen offset:2048 sc1 lds
  buffer_load_dwordx4 v5, s[24:27], s52 offen offset:3072 sc1 lds
  s_add_u32 s54, s54, s64
  s_cmp_eq_u32 s54, s68
  s_cselect_b32 s54, 0, s54
  s_waitcnt vmcnt(8)
  s_barrier
  s_add_u32 m0, s69, 73728
  s_add_u32 s52, s54, s87
  buffer_load_dwordx4 v2, s[24:27], s52 offen offset:0 sc1 lds
  buffer_load_dwordx4 v3, s[24:27], s52 offen offset:1024 sc1 lds
  buffer_load_dwordx4 v4, s[24:27], s52 offen offset:2048 sc1 lds
  buffer_load_dwordx4 v5, s[24:27], s52 offen offset:3072 sc1 lds
  s_add_u32 s54, s54, s64
  s_cmp_eq_u32 s54, s68
  s_cselect_b32 s54, 0, s54
  s_add_u32 m0, s70, 73728
  s_add_u32 s52, s55, 0
  buffer_load_dwordx4 v6, s[28:31], s52 offen offset:0 sc1 lds
  buffer_load_dwordx4 v7, s[28:31], s52 offen offset:1024 sc1 lds
  s_add_u32 s55, s55, 8192
  s_cmp_eq_u32 s55, s88
  s_cselect_b32 s55, 0, s55
  s_waitcnt vmcnt(10)
  s_barrier
  s_add_u32 m0, s69, 0
  s_add_u32 s52, s54, s87
  buffer_load_dwordx4 v2, s[24:27], s52 offen offset:0 sc1 lds
  buffer_load_dwordx4 v3, s[24:27], s52 offen offset:1024 sc1 lds
  buffer_load_dwordx4 v4, s[24:27], s52 offen offset:2048 sc1 lds
  buffer_load_dwordx4 v5, s[24:27], s52 offen offset:3072 sc1 lds
  s_add_u32 s54, s54, s64
  s_cmp_eq_u32 s54, s68
  s_cselect_b32 s54, 0, s54
  s_add_u32 m0, s70, 0
  s_add_u32 s52, s55, 0
  buffer_load_dwordx4 v6, s[28:31], s52 offen offset:0 sc1 lds
  buffer_load_dwordx4 v7, s[28:31], s52 offen offset:1024 sc1 lds
  s_add_u32 s55, s55, 8192
  s_cmp_eq_u32 s55, s88
  s_cselect_b32 s55, 0, s55
  s_waitcnt vmcnt(12)
  s_barrier
  s_add_u32 m0, s69, 24576
  s_add_u32 s52, s54, s87
  buffer_load_dwordx4 v2, s[24:27], s52 offen offset:0 sc1 lds
  buffer_load_dwordx4 v3, s[24:27], s52 offen offset:1024 sc1 lds
  buffer_load_dwordx4 v4, s[24:27], s52 offen offset:2048 sc1 lds
  buffer_load_dwordx4 v5, s[24:27], s52 offen offset:3072 sc1 lds
  s_add_u32 s54, s54, s64
  s_cmp_eq_u32 s54, s68
  s_cselect_b32 s54, 0, s54
  s_add_u32 m0, s70, 24576
  s_add_u32 s52, s55, 0
  buffer_load_dwordx4 v6, s[28:31], s52 offen offset:0 sc1 lds
  buffer_load_dwordx4 v7, s[28:31], s52 offen offset:1024 sc1 lds
  s_add_u32 s55, s55, 8192
  s_cmp_eq_u32 s55, s88
  s_cselect_b32 s55, 0, s55
  s_waitcnt vmcnt(12)
  s_barrier
  s_sub_u32 s53, s65, 6
  s_mov_b32 s51, 49152
L_ld_81:
  s_add_u32 m0, s69, s51
  s_add_u32 s52, s54, s87
  buffer_load_dwordx4 v2, s[24:27], s52 offen offset:0 sc1 lds
  buffer_load_dwordx4 v3, s[24:27], s52 offen offset:1024 sc1 lds
  buffer_load_dwordx4 v4, s[24:27], s52 offen offset:2048 sc1 lds
  buffer_load_dwordx4 v5, s[24:27], s52 offen offset:3072 sc1 lds
  s_add_u32 s54, s54, s64
  s_cmp_eq_u32 s54, s68
  s_cselect_b32 s54, 0, s54
  s_add_u32 s59, s70, s51
  s_mov_b32 m0, s59
  s_add_u32 s52, s55, 0
  buffer_load_dwordx4 v6, s[28:31], s52 offen offset:0 sc1 lds
  buffer_load_dwordx4 v7, s[28:31], s52 offen offset:1024 sc1 lds
  s_add_u32 s55, s55, 8192
  s_cmp_eq_u32 s55, s88
  s_cselect_b32 s55, 0, s55
  s_add_u32 s51, s51, 24576
  s_cmp_eq_u32 s51, 98304
  s_cselect_b32 s51, 0, s51
  s_waitcnt vmcnt(12)
  s_barrier
  s_sub_u32 s53, s53, 1
  s_cmp_lg_u32 s53, 0
  s_cbranch_scc1 L_ld_81
  s_waitcnt vmcnt(6)
  s_barrier
  s_waitcnt vmcnt(0)
  s_barrier
  s_waitcnt vmcnt(0)
  s_barrier
  s_cmp_lg_u32 s71, 0
  s_cbranch_scc1 L_aux_82
  s_cmp_lg_u32 s48, 4
  s_cbranch_scc1 L_aux_82
  s_add_u32 s60, s73, 176
  s_lshl_b32 s60, s60, 7
  v_mov_b32 v10, 0
  s_mov_b32 s94, 0x20000
L_poll_83:
  buffer_load_dword v11, v10, s[76:79], s60 offen sc1
  s_waitcnt vmcnt(0)
  v_readfirstlane_b32 s52, v11
  s_nop 3
  s_cmp_ge_u32 s52, 64
  s_cbranch_scc1 L_pok_84
  s_sub_u32 s94, s94, 1
  s_cmp_eq_u32 s94, 0
  s_cbranch_scc1 L_pok_84
  s_sleep 1
  s_branch L_poll_83
L_pok_84:
L_aux_82:
  s_barrier
  s_cmp_lg_u32 s48, 4
  s_cbranch_scc1 L_nsig_85
  s_lshl_b32 s60, s71, 4
  s_add_u32 s60, s60, s74
  s_add_u32 s60, s60, 64
  s_lshl_b32 s60, s60, 7
  v_mov_b32 v10, 0
  v_mov_b32 v11, 1
  s_mov_b64 exec, 1
  buffer_atomic_add v11, v10, s[76:79], s60 offen sc1
  s_mov_b64 exec, -1
L_nsig_85:
  s_mul_i32 s60, s72, 262144
  s_add_u32 s24, s20, 4194304
  s_addc_u32 s25, s21, 0
  s_add_u32 s24, s24, s60
  s_addc_u32 s25, s25, 0
  s_mov_b32 s26, 262144
  s_mov_b32 s27, 0x00020000
  v_lshlrev_b32 v2, 4, v1
  v_mov_b32 v3, v2
  v_mov_b32 v4, v2
  v_mov_b32 v5, v2
  s_lshl_b32 s69, s89, 12
  s_mov_b32 s87, s69
  s_mov_b32 s64, 16384
  s_mul_i32 s60, s73, 224
  s_and_b32 s61, s73, 1
  s_lshl_b32 s61, s61, 5
  s_sub_u32 s60, s60, s61
  s_lshl_b32 s61, s60, 1
  s_sub_u32 s63, 7340032, s61
  s_add_u32 s28, s12, s61
  s_addc_u32 s29, s13, 0
  s_mov_b32 s30, s63
  s_mov_b32 s31, 0x00020000
  v_lshrrev_b32 v10, 3, v1
  v_and_b32 v11, 7, v1
  v_bfe_u32 v12, v1, 4, 1
  s_lshl_b32 s52, s89, 4
  v_add_u32 v13, s52, v10
  s_mov_b32 s59, 7168
  v_mul_lo_u32 v13, v13, s59
  v_lshlrev_b32 v14, 1, v12
  v_xor_b32 v14, v14, v11
  v_lshl_add_u32 v6, v14, 4, v13
  v_or_b32 v14, 2, v12
  v_lshlrev_b32 v14, 1, v14
  v_xor_b32 v14, v14, v11
  v_lshl_add_u32 v7, v14, 4, v13
  v_add_u32 v7, 56320, v7
  s_lshl_b32 s70, s89, 11
  s_add_u32 s70, s70, 16384
  s_mov_b32 s65, 16
  s_mul_i32 s63, s72, 0
  s_mul_i32 s52, s73, 0
  s_add_u32 s63, s63, s52
  s_and_b32 s63, s63, 15
  s_mul_i32 s54, s63, s64
  s_mul_i32 s68, s65, s64
  s_mul_i32 s55, s63, 458752
  s_mul_i32 s88, s65, 458752
  s_add_u32 m0, s70, 0
  s_add_u32 s52, s55, 0
  buffer_load_dwordx4 v6, s[28:31], s52 offen offset:0  lds
  buffer_load_dwordx4 v7, s[28:31], s52 offen offset:1024  lds
  s_add_u32 m0, s70, 8192
  s_add_u32 s52, s55, 128
  buffer_load_dwordx4 v6, s[28:31], s52 offen offset:0  lds
  buffer_load_dwordx4 v7, s[28:31], s52 offen offset:1024  lds
  s_add_u32 m0, s70, 16384
  s_add_u32 s52, s55, 256
  buffer_load_dwordx4 v6, s[28:31], s52 offen offset:0  lds
  buffer_load_dwordx4 v7, s[28:31], s52 offen offset:1024  lds
  s_add_u32 m0, s70, 24576
  s_add_u32 s52, s55, 384
  buffer_load_dwordx4 v6, s[28:31], s52 offen offset:0  lds
  buffer_load_dwordx4 v7, s[28:31], s52 offen offset:1024  lds
  s_add_u32 s55, s55, 458752
  s_cmp_eq_u32 s55, s88
  s_cselect_b32 s55, 0, s55
  s_add_u32 m0, s70, 49152
  s_add_u32 s52, s55, 0
  buffer_load_dwordx4 v6, s[28:31], s52 offen offset:0  lds
  buffer_load_dwordx4 v7, s[28:31], s52 offen offset:1024  lds
  s_add_u32 m0, s70, 57344
  s_add_u32 s52, s55, 128
  buffer_load_dwordx4 v6, s[28:31], s52 offen offset:0  lds
  buffer_load_dwordx4 v7, s[28:31], s52 offen offset:1024  lds
  s_add_u32 m0, s70, 65536
  s_add_u32 s52, s55, 256
  buffer_load_dwordx4 v6, s[28:31], s52 offen offset:0  lds
  buffer_load_dwordx4 v7, s[28:31], s52 offen offset:1024  lds
  s_add_u32 m0, s70, 73728
  s_add_u32 s52, s55, 384
  buffer_load_dwordx4 v6, s[28:31], s52 offen offset:0  lds
  buffer_load_dwordx4 v7, s[28:31], s52 offen offset:1024  lds
  s_add_u32 s55, s55, 458752
  s_cmp_eq_u32 s55, s88
  s_cselect_b32 s55, 0, s55
  s_cmp_lg_u32 s48, 4
  s_cbranch_scc1 L_oth_86
  s_lshl_b32 s60, s71, 4
  s_add_u32 s60, s60, s72
  s_add_u32 s60, s60, 64
  s_lshl_b32 s60, s60, 7
  v_mov_b32 v120, 0
  s_mov_b32 s94, 0x20000
L_poll_88:
  buffer_load_dword v121, v120, s[76:79], s60 offen sc1
  s_waitcnt vmcnt(0)
  v_readfirstlane_b32 s52, v121
  s_nop 3
  s_cmp_ge_u32 s52, 16
  s_cbranch_scc1 L_pok_89
  s_sub_u32 s94, s94, 1
  s_cmp_eq_u32 s94, 0
  s_cbranch_scc1 L_pok_89
  s_sleep 1
  s_branch L_poll_88
L_pok_89:
  s_lshl_b32 s52, s71, 2
  s_add_u32 s52, s52, 2
  v_mov_b32 v10, 152576
  v_mov_b32 v11, s52
  ds_write_b32 v10, v11
  s_waitcnt lgkmcnt(0)
  s_branch L_wdn_87
L_oth_86:
  s_lshl_b32 s63, s71, 2
  s_add_u32 s63, s63, 2
  v_mov_b32 v10, 152576
  s_mov_b32 s94, 0x1000000
L_fw_90:
  ds_read_b32 v11, v10
  s_waitcnt lgkmcnt(0)
  v_readfirstlane_b32 s52, v11
  s_nop 3
  s_cmp_ge_u32 s52, s63
  s_cbranch_scc1 L_fok_91
  s_sub_u32 s94, s94, 1
  s_cmp_eq_u32 s94, 0
  s_cbranch_scc1 L_fok_91
  s_sleep 1
  s_branch L_fw_90
L_fok_91:
L_wdn_87:
  s_add_u32 m0, s69, 0
  s_add_u32 s52, s54, s87
  buffer_load_dwordx4 v2, s[24:27], s52 offen offset:0 sc1 lds
  buffer_load_dwordx4 v3, s[24:27], s52 offen offset:1024 sc1 lds
  buffer_load_dwordx4 v4, s[24:27], s52 offen offset:2048 sc1 lds
  buffer_load_dwordx4 v5, s[24:27], s52 offen offset:3072 sc1 lds
  s_add_u32 s54, s54, s64
  s_cmp_eq_u32 s54, s68
  s_cselect_b32 s54, 0, s54
  s_add_u32 m0, s69, 49152
  s_add_u32 s52, s54, s87
  buffer_load_dwordx4 v2, s[24:27], s52 offen offset:0 sc1 lds
  buffer_load_dwordx4 v3, s[24:27], s52 offen offset:1024 sc1 lds
  buffer_load_dwordx4 v4, s[24:27], s52 offen offset:2048 sc1 lds
  buffer_load_dwordx4 v5, s[24:27], s52 offen offset:3072 sc1 lds
  s_add_u32 s54, s54, s64
  s_cmp_eq_u32 s54, s68
  s_cselect_b32 s54, 0, s54
  s_waitcnt vmcnt(4)
  s_barrier
  s_add_u32 m0, s69, 98304
  s_add_u32 s52, s54, s87
  buffer_load_dwordx4 v2, s[24:27], s52 offen offset:0 sc1 lds
  buffer_load_dwordx4 v3, s[24:27], s52 offen offset:1024 sc1 lds
  buffer_load_dwordx4 v4, s[24:27], s52 offen offset:2048 sc1 lds
  buffer_load_dwordx4 v5, s[24:27], s52 offen offset:3072 sc1 lds
  s_add_u32 s54, s54, s64
  s_cmp_eq_u32 s54, s68
  s_cselect_b32 s54, 0, s54
  s_add_u32 m0, s70, 98304
  s_add_u32 s52, s55, 0
  buffer_load_dwordx4 v6, s[28:31], s52 offen offset:0  lds
  buffer_load_dwordx4 v7, s[28:31], s52 offen offset:1024  lds
  s_add_u32 m0, s70, 106496
  s_add_u32 s52, s55, 128
  buffer_load_dwordx4 v6, s[28:31], s52 offen offset:0  lds
  buffer_load_dwordx4 v7, s[28:31], s52 offen offset:1024  lds
  s_add_u32 m0, s70, 114688
  s_add_u32 s52, s55, 256
  buffer_load_dwordx4 v6, s[28:31], s52 offen offset:0  lds
  buffer_load_dwordx4 v7, s[28:31], s52 offen offset:1024  lds
  s_add_u32 m0, s70, 122880
  s_add_u32 s52, s55, 384
  buffer_load_dwordx4 v6, s[28:31], s52 offen offset:0  lds
  buffer_load_dwordx4 v7, s[28:31], s52 offen offset:1024  lds
  s_add_u32 s55, s55, 458752
  s_cmp_eq_u32 s55, s88
  s_cselect_b32 s55, 0, s55
  s_waitcnt vmcnt(12)
  s_barrier
  s_add_u32 m0, s69, 0
  s_add_u32 s52, s54, s87
  buffer_load_dwordx4 v2, s[24:27], s52 offen offset:0 sc1 lds
  buffer_load_dwordx4 v3, s[24:27], s52 offen offset:1024 sc1 lds
  buffer_load_dwordx4 v4, s[24:27], s52 offen offset:2048 sc1 lds
  buffer_load_dwordx4 v5, s[24:27], s52 offen offset:3072 sc1 lds
  s_add_u32 s54, s54, s64
  s_cmp_eq_u32 s54, s68
  s_cselect_b32 s54, 0, s54
  s_add_u32 m0, s70, 0
  s_add_u32 s52, s55, 0
  buffer_load_dwordx4 v6, s[28:31], s52 offen offset:0  lds
  buffer_load_dwordx4 v7, s[28:31], s52 offen offset:1024  lds
  s_add_u32 m0, s70, 8192
  s_add_u32 s52, s55, 128
  buffer_load_dwordx4 v6, s[28:31], s52 offen offset:0  lds
  buffer_load_dwordx4 v7, s[28:31], s52 offen offset:1024  lds
  s_add_u32 m0, s70, 16384
  s_add_u32 s52, s55, 256
  buffer_load_dwordx4 v6, s[28:31], s52 offen offset:0  lds
  buffer_load_dwordx4 v7, s[28:31], s52 offen offset:1024  lds
  s_add_u32 m0, s70, 24576
  s_add_u32 s52, s55, 384
  buffer_load_dwordx4 v6, s[28:31], s52 offen offset:0  lds
  buffer_load_dwordx4 v7, s[28:31], s52 offen offset:1024  lds
  s_add_u32 s55, s55, 458752
  s_cmp_eq_u32 s55, s88
  s_cselect_b32 s55, 0, s55
  s_waitcnt vmcnt(12)
  s_barrier
  s_sub_u32 s53, s65, 4
  s_mov_b32 s51, 49152
L_ld_92:
  s_add_u32 m0, s69, s51
  s_add_u32 s52, s54, s87
  buffer_load_dwordx4 v2, s[24:27], s52 offen offset:0 sc1 lds
  buffer_load_dwordx4 v3, s[24:27], s52 offen offset:1024 sc1 lds
  buffer_load_dwordx4 v4, s[24:27], s52 offen offset:2048 sc1 lds
  buffer_load_dwordx4 v5, s[24:27], s52 offen offset:3072 sc1 lds
  s_add_u32 s54, s54, s64
  s_cmp_eq_u32 s54, s68
  s_cselect_b32 s54, 0, s54
  s_add_u32 s59, s70, s51
  s_mov_b32 m0, s59
  s_add_u32 s52, s55, 0
  buffer_load_dwordx4 v6, s[28:31], s52 offen offset:0  lds
  buffer_load_dwordx4 v7, s[28:31], s52 offen offset:1024  lds
  s_add_u32 m0, s59, 8192
  s_add_u32 s52, s55, 128
  buffer_load_dwordx4 v6, s[28:31], s52 offen offset:0  lds
  buffer_load_dwordx4 v7, s[28:31], s52 offen offset:1024  lds
  s_add_u32 m0, s59, 16384
  s_add_u32 s52, s55, 256
  buffer_load_dwordx4 v6, s[28:31], s52 offen offset:0  lds
  buffer_load_dwordx4 v7, s[28:31], s52 offen offset:1024  lds
  s_add_u32 m0, s59, 24576
  s_add_u32 s52, s55, 384
  buffer_load_dwordx4 v6, s[28:31], s52 offen offset:0  lds
  buffer_load_dwordx4 v7, s[28:31], s52 offen offset:1024  lds
  s_add_u32 s55, s55, 458752
  s_cmp_eq_u32 s55, s88
  s_cselect_b32 s55, 0, s55
  s_add_u32 s51, s51, 49152
  s_cmp_eq_u32 s51, 147456
  s_cselect_b32 s51, 0, s51
  s_waitcnt vmcnt(12)
  s_barrier
  s_sub_u32 s53, s53, 1
  s_cmp_lg_u32 s53, 0
  s_cbranch_scc1 L_ld_92
  s_waitcnt vmcnt(0)
  s_barrier
  s_waitcnt vmcnt(0)
  s_barrier
  s_cmp_lg_u32 s71, 0
  s_cbranch_scc1 L_aux_93
  s_cmp_lg_u32 s48, 4
  s_cbranch_scc1 L_aux_93
  s_add_u32 s60, s75, 192
  s_lshl_b32 s60, s60, 7
  v_mov_b32 v10, 0
  s_mov_b32 s94, 0x20000
L_poll_94:
  buffer_load_dword v11, v10, s[76:79], s60 offen sc1
  s_waitcnt vmcnt(0)
  v_readfirstlane_b32 s52, v11
  s_nop 3
  s_cmp_ge_u32 s52, 64
  s_cbranch_scc1 L_pok_95
  s_sub_u32 s94, s94, 1
  s_cmp_eq_u32 s94, 0
  s_cbranch_scc1 L_pok_95
  s_sleep 1
  s_branch L_poll_94
L_pok_95:
L_aux_93:
  s_barrier
  s_cmp_lg_u32 s48, 4
  s_cbranch_scc1 L_nsig_96
  s_lshl_b32 s60, s71, 4
  s_add_u32 s60, s60, s72
  s_add_u32 s60, s60, 96
  s_lshl_b32 s60, s60, 7
  v_mov_b32 v10, 0
  v_mov_b32 v11, 1
  s_mov_b64 exec, 1
  buffer_atomic_add v11, v10, s[76:79], s60 offen sc1
  s_mov_b64 exec, -1
L_nsig_96:
  s_lshl_b32 s61, s75, 7
  s_mul_i32 s60, s74, 917504
  s_add_u32 s24, s20, 12582912
  s_addc_u32 s25, s21, 0
  s_add_u32 s24, s24, s60
  s_addc_u32 s25, s25, 0
  s_mov_b32 s26, 917504
  s_mov_b32 s27, 0x00020000
  s_sub_u32 s63, 7340032, s61
  s_add_u32 s28, s14, s61
  s_addc_u32 s29, s15, 0
  s_mov_b32 s30, s63
  s_mov_b32 s31, 0x00020000
  s_mov_b32 s65, 56
  s_mul_i32 s63, s74, 0
  s_mul_i32 s52, s75, 0
  s_add_u32 s63, s63, s52
  v_lshlrev_b32 v2, 4, v1
  v_mov_b32 v3, v2
  v_mov_b32 v4, v2
  v_mov_b32 v5, v2
  s_lshl_b32 s69, s89, 12
  s_mov_b32 s87, s69
  s_mov_b32 s64, 16384
  s_mul_i32 s61, s75, 458752
  s_add_u32 s28, s20, 41943040
  s_addc_u32 s29, s21, 0
  s_add_u32 s28, s28, s61
  s_addc_u32 s29, s29, 0
  s_mov_b32 s30, 458752
  s_mov_b32 s31, 0x00020000
  v_lshlrev_b32 v6, 4, v1
  s_lshl_b32 s52, s89, 11
  v_add_u32 v6, s52, v6
  v_mov_b32 v7, v6
  s_lshl_b32 s70, s89, 11
  s_add_u32 s70, s70, 16384
  s_mul_i32 s54, s63, s64
  s_mul_i32 s68, s65, s64
  s_mul_i32 s55, s63, 8192
  s_mul_i32 s88, s65, 8192
  s_add_u32 m0, s70, 0
  s_add_u32 s52, s55, 0
  buffer_load_dwordx4 v6, s[28:31], s52 offen offset:0 sc1 lds
  buffer_load_dwordx4 v7, s[28:31], s52 offen offset:1024 sc1 lds
  s_add_u32 s55, s55, 8192
  s_cmp_eq_u32 s55, s88
  s_cselect_b32 s55, 0, s55
  s_add_u32 m0, s70, 24576
  s_add_u32 s52, s55, 0
  buffer_load_dwordx4 v6, s[28:31], s52 offen offset:0 sc1 lds
  buffer_load_dwordx4 v7, s[28:31], s52 offen offset:1024 sc1 lds
  s_add_u32 s55, s55, 8192
  s_cmp_eq_u32 s55, s88
  s_cselect_b32 s55, 0, s55
  s_add_u32 m0, s70, 49152
  s_add_u32 s52, s55, 0
  buffer_load_dwordx4 v6, s[28:31], s52 offen offset:0 sc1 lds
  buffer_load_dwordx4 v7, s[28:31], s52 offen offset:1024 sc1 lds
  s_add_u32 s55, s55, 8192
  s_cmp_eq_u32 s55, s88
  s_cselect_b32 s55, 0, s55
  s_cmp_lg_u32 s48, 4
  s_cbranch_scc1 L_oth_97
  s_lshl_b32 s60, s71, 4
  s_add_u32 s60, s60, s74
  s_add_u32 s60, s60, 96
  s_lshl_b32 s60, s60, 7
  v_mov_b32 v120, 0
  s_mov_b32 s94, 0x20000
L_poll_99:
  buffer_load_dword v121, v120, s[76:79], s60 offen sc1
  s_waitcnt vmcnt(0)
  v_readfirstlane_b32 s52, v121
  s_nop 3
  s_cmp_ge_u32 s52, 16
  s_cbranch_scc1 L_pok_100
  s_sub_u32 s94, s94, 1
  s_cmp_eq_u32 s94, 0
  s_cbranch_scc1 L_pok_100
  s_sleep 1
  s_branch L_poll_99
L_pok_100:
  s_lshl_b32 s52, s71, 2
  s_add_u32 s52, s52, 3
  v_mov_b32 v10, 152576
  v_mov_b32 v11, s52
  ds_write_b32 v10, v11
  s_waitcnt lgkmcnt(0)
  s_branch L_wdn_98
L_oth_97:
  s_lshl_b32 s63, s71, 2
  s_add_u32 s63, s63, 3
  v_mov_b32 v10, 152576
  s_mov_b32 s94, 0x1000000
L_fw_101:
  ds_read_b32 v11, v10
  s_waitcnt lgkmcnt(0)
  v_readfirstlane_b32 s52, v11
  s_nop 3
  s_cmp_ge_u32 s52, s63
  s_cbranch_scc1 L_fok_102
  s_sub_u32 s94, s94, 1
  s_cmp_eq_u32 s94, 0
  s_cbranch_scc1 L_fok_102
  s_sleep 1
  s_branch L_fw_101
L_fok_102:
L_wdn_98:
  s_add_u32 m0, s69, 0
  s_add_u32 s52, s54, s87
  buffer_load_dwordx4 v2, s[24:27], s52 offen offset:0 sc1 lds
  buffer_load_dwordx4 v3, s[24:27], s52 offen offset:1024 sc1 lds
  buffer_load_dwordx4 v4, s[24:27], s52 offen offset:2048 sc1 lds
  buffer_load_dwordx4 v5, s[24:27], s52 offen offset:3072 sc1 lds
  s_add_u32 s54, s54, s64
  s_cmp_eq_u32 s54, s68
  s_cselect_b32 s54, 0, s54
  s_add_u32 m0, s69, 24576
  s_add_u32 s52, s54, s87
  buffer_load_dwordx4 v2, s[24:27], s52 offen offset:0 sc1 lds
  buffer_load_dwordx4 v3, s[24:27], s52 offen offset:1024 sc1 lds
  buffer_load_dwordx4 v4, s[24:27], s52 offen offset:2048 sc1 lds
  buffer_load_dwordx4 v5, s[24:27], s52 offen offset:3072 sc1 lds
  s_add_u32 s54, s54, s64
  s_cmp_eq_u32 s54, s68
  s_cselect_b32 s54, 0, s54
  s_add_u32 m0, s69, 49152
  s_add_u32 s52, s54, s87
  buffer_load_dwordx4 v2, s[24:27], s52 offen offset:0 sc1 lds
  buffer_load_dwordx4 v3, s[24:27], s52 offen offset:1024 sc1 lds
  buffer_load_dwordx4 v4, s[24:27], s52 offen offset:2048 sc1 lds
  buffer_load_dwordx4 v5, s[24:27], s52 offen offset:3072 sc1 lds
  s_add_u32 s54, s54, s64
  s_cmp_eq_u32 s54, s68
  s_cselect_b32 s54, 0, s54
  s_waitcnt vmcnt(8)
  s_barrier
  s_add_u32 m0, s69, 73728
  s_add_u32 s52, s54, s87
  buffer_load_dwordx4 v2, s[24:27], s52 offen offset:0 sc1 lds
  buffer_load_dwordx4 v3, s[24:27], s52 offen offset:1024 sc1 lds
  buffer_load_dwordx4 v4, s[24:27], s52 offen offset:2048 sc1 lds
  buffer_load_dwordx4 v5, s[24:27], s52 offen offset:3072 sc1 lds
  s_add_u32 s54, s54, s64
  s_cmp_eq_u32 s54, s68
  s_cselect_b32 s54, 0, s54
  s_add_u32 m0, s70, 73728
  s_add_u32 s52, s55, 0
  buffer_load_dwordx4 v6, s[28:31], s52 offen offset:0 sc1 lds
  buffer_load_dwordx4 v7, s[28:31], s52 offen offset:1024 sc1 lds
  s_add_u32 s55, s55, 8192
  s_cmp_eq_u32 s55, s88
  s_cselect_b32 s55, 0, s55
  s_waitcnt vmcnt(10)
  s_barrier
  s_add_u32 m0, s69, 0
  s_add_u32 s52, s54, s87
  buffer_load_dwordx4 v2, s[24:27], s52 offen offset:0 sc1 lds
  buffer_load_dwordx4 v3, s[24:27], s52 offen offset:1024 sc1 lds
  buffer_load_dwordx4 v4, s[24:27], s52 offen offset:2048 sc1 lds
  buffer_load_dwordx4 v5, s[24:27], s52 offen offset:3072 sc1 lds
  s_add_u32 s54, s54, s64
  s_cmp_eq_u32 s54, s68
  s_cselect_b32 s54, 0, s54
  s_add_u32 m0, s70, 0
  s_add_u32 s52, s55, 0
  buffer_load_dwordx4 v6, s[28:31], s52 offen offset:0 sc1 lds
  buffer_load_dwordx4 v7, s[28:31], s52 offen offset:1024 sc1 lds
  s_add_u32 s55, s55, 8192
  s_cmp_eq_u32 s55, s88
  s_cselect_b32 s55, 0, s55
  s_waitcnt vmcnt(12)
  s_barrier
  s_add_u32 m0, s69, 24576
  s_add_u32 s52, s54, s87
  buffer_load_dwordx4 v2, s[24:27], s52 offen offset:0 sc1 lds
  buffer_load_dwordx4 v3, s[24:27], s52 offen offset:1024 sc1 lds
  buffer_load_dwordx4 v4, s[24:27], s52 offen offset:2048 sc1 lds
  buffer_load_dwordx4 v5, s[24:27], s52 offen offset:3072 sc1 lds
  s_add_u32 s54, s54, s64
  s_cmp_eq_u32 s54, s68
  s_cselect_b32 s54, 0, s54
  s_add_u32 m0, s70, 24576
  s_add_u32 s52, s55, 0
  buffer_load_dwordx4 v6, s[28:31], s52 offen offset:0 sc1 lds
  buffer_load_dwordx4 v7, s[28:31], s52 offen offset:1024 sc1 lds
  s_add_u32 s55, s55, 8192
  s_cmp_eq_u32 s55, s88
  s_cselect_b32 s55, 0, s55
  s_waitcnt vmcnt(12)
  s_barrier
  s_sub_u32 s53, s65, 6
  s_mov_b32 s51, 49152
L_ld_103:
  s_add_u32 m0, s69, s51
  s_add_u32 s52, s54, s87
  buffer_load_dwordx4 v2, s[24:27], s52 offen offset:0 sc1 lds
  buffer_load_dwordx4 v3, s[24:27], s52 offen offset:1024 sc1 lds
  buffer_load_dwordx4 v4, s[24:27], s52 offen offset:2048 sc1 lds
  buffer_load_dwordx4 v5, s[24:27], s52 offen offset:3072 sc1 lds
  s_add_u32 s54, s54, s64
  s_cmp_eq_u32 s54, s68
  s_cselect_b32 s54, 0, s54
  s_add_u32 s59, s70, s51
  s_mov_b32 m0, s59
  s_add_u32 s52, s55, 0
  buffer_load_dwordx4 v6, s[28:31], s52 offen offset:0 sc1 lds
  buffer_load_dwordx4 v7, s[28:31], s52 offen offset:1024 sc1 lds
  s_add_u32 s55, s55, 8192
  s_cmp_eq_u32 s55, s88
  s_cselect_b32 s55, 0, s55
  s_add_u32 s51, s51, 24576
  s_cmp_eq_u32 s51, 98304
  s_cselect_b32 s51, 0, s51
  s_waitcnt vmcnt(12)
  s_barrier
  s_sub_u32 s53, s53, 1
  s_cmp_lg_u32 s53, 0
  s_cbranch_scc1 L_ld_103
  s_waitcnt vmcnt(6)
  s_barrier
  s_waitcnt vmcnt(0)
  s_barrier
  s_waitcnt vmcnt(0)
  s_barrier
  s_barrier
  s_cmp_lg_u32 s48, 4
  s_cbranch_scc1 L_nsig_104
  s_cmp_lg_u32 s71, 0
  s_cbranch_scc1 L_nsig_104
  s_add_u32 s60, s74, 128
  s_lshl_b32 s60, s60, 7
  v_mov_b32 v10, 0
  v_mov_b32 v11, 1
  s_mov_b64 exec, 1
  buffer_atomic_add v11, v10, s[76:79], s60 offen sc1
  s_mov_b64 exec, -1
L_nsig_104:
  s_add_u32 s71, s71, 1
  s_cmp_ge_u32 s71, 2
  s_cbranch_scc1 L_lend_105
  s_mul_i32 s60, s72, 262144
  s_cmp_lg_u32 s71, 0
  s_cbranch_scc1 L_la1_106
  s_add_u32 s24, s4, s60
  s_addc_u32 s25, s5, 0
  s_mov_b32 s26, 262144
  s_mov_b32 s27, 0x00020000
  v_lshrrev_b32 v10, 3, v1
  v_and_b32 v11, 7, v1
  v_lshrrev_b32 v12, 4, v1
  v_lshlrev_b32 v13, 11, v10
  v_or_b32 v14, 0, v12
  v_xor_b32 v14, v14, v11
  v_lshl_add_u32 v2, v14, 4, v13
  v_or_b32 v14, 4, v12
  v_xor_b32 v14, v14, v11
  v_lshl_add_u32 v3, v14, 4, v13
  v_add_u32 v3, 15360, v3
  v_or_b32 v14, 0, v12
  v_xor_b32 v14, v14, v11
  v_lshl_add_u32 v4, v14, 4, v13
  v_add_u32 v4, 30720, v4
  v_or_b32 v14, 4, v12
  v_xor_b32 v14, v14, v11
  v_lshl_add_u32 v5, v14, 4, v13
  v_add_u32 v5, 46080, v5
  s_lshl_b32 s69, s89, 12
  s_mov_b32 s64, 128
  s_lshl_b32 s87, s89, 16
  s_branch L_laj_107
L_la1_106:
  s_add_u32 s24, s20, 8388608
  s_addc_u32 s25, s21, 0
  s_add_u32 s24, s24, s60
  s_addc_u32 s25, s25, 0
  s_mov_b32 s26, 262144
  s_mov_b32 s27, 0x00020000
  v_lshlrev_b32 v2, 4, v1
  v_mov_b32 v3, v2
  v_mov_b32 v4, v2
  v_mov_b32 v5, v2
  s_lshl_b32 s69, s89, 12
  s_mov_b32 s87, s69
  s_mov_b32 s64, 16384
L_laj_107:
  s_lshl_b32 s60, s73, 7
  s_sub_u32 s63, 6291456, s60
  s_add_u32 s28, s6, s60
  s_addc_u32 s29, s7, 0
  s_mov_b32 s30, s63
  s_mov_b32 s31, 0x00020000
  v_lshrrev_b32 v10, 3, v1
  v_and_b32 v11, 7, v1
  v_bfe_u32 v12, v1, 4, 1
  s_lshl_b32 s52, s89, 4
  v_add_u32 v13, s52, v10
  s_mov_b32 s59, 6144
  v_mul_lo_u32 v13, v13, s59
  v_lshlrev_b32 v14, 1, v12
  v_xor_b32 v14, v14, v11
  v_lshl_add_u32 v6, v14, 4, v13
  v_or_b32 v14, 2, v12
  v_lshlrev_b32 v14, 1, v14
  v_xor_b32 v14, v14, v11
  v_lshl_add_u32 v7, v14, 4, v13
  v_add_u32 v7, 48128, v7
  s_lshl_b32 s70, s89, 11
  s_add_u32 s70, s70, 16384
  s_mov_b32 s65, 16
  s_cmp_lg_u32 s71, 0
  s_cbranch_scc1 L_r1_108
  s_mul_i32 s63, s72, 1
  s_mul_i32 s52, s73, 1
  s_add_u32 s63, s63, s52
  s_and_b32 s63, s63, 15
  s_branch L_rd_109
L_r1_108:
  s_mul_i32 s63, s72, 0
  s_mul_i32 s52, s73, 0
  s_add_u32 s63, s63, s52
  s_and_b32 s63, s63, 15
L_rd_109:
  s_mul_i32 s54, s63, s64
  s_mul_i32 s68, s65, s64
  s_mul_i32 s55, s63, 393216
  s_mul_i32 s88, s65, 393216
  s_add_u32 m0, s70, 0
  s_add_u32 s52, s55, 0
  buffer_load_dwordx4 v6, s[28:31], s52 offen offset:0  lds
  buffer_load_dwordx4 v7, s[28:31], s52 offen offset:1024  lds
  s_add_u32 m0, s70, 8192
  s_add_u32 s52, s55, 2048
  buffer_load_dwordx4 v6, s[28:31], s52 offen offset:0  lds
  buffer_load_dwordx4 v7, s[28:31], s52 offen offset:1024  lds
  s_add_u32 m0, s70, 16384
  s_add_u32 s52, s55, 4096
  buffer_load_dwordx4 v6, s[28:31], s52 offen offset:0  lds
  buffer_load_dwordx4 v7, s[28:31], s52 offen offset:1024  lds
  s_add_u32 s55, s55, 393216
  s_cmp_eq_u32 s55, s88
  s_cselect_b32 s55, 0, s55
  s_add_u32 m0, s70, 40960
  s_add_u32 s52, s55, 0
  buffer_load_dwordx4 v6, s[28:31], s52 offen offset:0  lds
  buffer_load_dwordx4 v7, s[28:31], s52 offen offset:1024  lds
  s_add_u32 m0, s70, 49152
  s_add_u32 s52, s55, 2048
  buffer_load_dwordx4 v6, s[28:31], s52 offen offset:0  lds
  buffer_load_dwordx4 v7, s[28:31], s52 offen offset:1024  lds
  s_add_u32 m0, s70, 57344
  s_add_u32 s52, s55, 4096
  buffer_load_dwordx4 v6, s[28:31], s52 offen offset:0  lds
  buffer_load_dwordx4 v7, s[28:31], s52 offen offset:1024  lds
  s_add_u32 s55, s55, 393216
  s_cmp_eq_u32 s55, s88
  s_cselect_b32 s55, 0, s55
  s_branch L_llayer_61
L_lend_105:
  s_endpgm
L_done:
  s_endpgm
L_code_end:
.section .rodata,"a"
.p2align 6
.amdhsa_kernel interleave_layers__linear_attn_block__dense_activation_silu__prompt_kernel
  .amdhsa_next_free_vgpr 256
  .amdhsa_next_free_sgpr 96
  .amdhsa_accum_offset 256
  .amdhsa_group_segment_fixed_size 0
  .amdhsa_kernarg_size 72
  .amdhsa_user_sgpr_count 2
  .amdhsa_user_sgpr_kernarg_segment_ptr 1
  .amdhsa_system_sgpr_workgroup_id_x 1
.end_amdhsa_kernel
```
